```python
import torch

def _softmax(x, axis=-1):
    return torch.softmax(x, dim=axis)
def _gelu(x):
    return torch.nn.functional.gelu(x, approximate="tanh")
def _silu(x):
    return torch.nn.functional.silu(x)
def _sigmoid(x):
    return torch.sigmoid(x)
def _layernorm(x, axis=-1, eps=1e-5):
    m = x.mean(dim=axis, keepdim=True)
    v = x.var(dim=axis, keepdim=True, unbiased=False)
    return (x - m) / torch.sqrt(v + eps)
def _scatter_add(tgt, idx, src, axis=0):
    return tgt.clone().index_add_(axis, idx, src)
def _segment_sum(src, seg, n):
    out = torch.zeros((n,) + src.shape[1:], dtype=src.dtype)
    return out.index_add_(0, seg, src)
def _pad(x, pw):
    flat = tuple(v for pair in reversed(pw) for v in pair)
    return torch.nn.functional.pad(x, flat)

kernel_name = 'standalone__mha_softmax__near_ridge'

def setup_inputs():

    _w = (lambda a: (lambda t: t.to(torch.bfloat16) if t.is_floating_point() else t)(torch.as_tensor(a)))
    B, H, Sq, Sk, D = 16, 32, 496, 512, 128
    return {
        "q": _w((lambda *s: torch.randn(*s, dtype=torch.bfloat16) * 0.8)(B, H, Sq, D)),
        "k": _w((lambda *s: torch.randn(*s, dtype=torch.bfloat16) * 0.8)(B, H, Sk, D)),
        "v": _w((lambda *s: torch.randn(*s, dtype=torch.bfloat16) * 0.05)(B, H, Sk, D)),
    }

def reference(q, k, v):
    scale = q.shape[-1] ** -0.5
    scores = torch.einsum("bhqd,bhkd->bhqk", q, k) * scale
    p = _softmax(scores, axis=-1)
    return torch.einsum("bhqk,bhkd->bhqd", p, v)
```

```asm
; @launch grid=(256,1,1) block=(256,1,1) lds=163840
.amdgcn_target "amdgcn-amd-amdhsa--gfx950"
.text
.globl standalone__mha_softmax__near_ridge_kernel
.p2align 8
.type standalone__mha_softmax__near_ridge_kernel,@function
standalone__mha_softmax__near_ridge_kernel:
  s_cmp_ge_u32 s2, 256
  s_cbranch_scc1 L_end
  s_load_dwordx8 s[32:39], s[0:1], 0
  v_lshrrev_b32 v31, 6, v0
  v_and_b32 v30, 63, v0
  s_and_b32 s27, s2, 7
  v_readfirstlane_b32 s26, v31
  s_getpc_b64 s[28:29]
L_pfbase:
  v_lshlrev_b32 v36, 7, v30
  s_lshl_b32 s47, s26, 13
  v_add_u32 v36, s47, v36
  v_add_u32 v39, 0x8000, v36
  v_min_u32 v36, L_codeend - L_pfbase, v36
  v_min_u32 v39, L_codeend - L_pfbase, v39
  v_mov_b32 v37, s29
  v_mov_b32 v41, s29
  v_add_co_u32 v36, vcc, s28, v36
  s_nop 1
  v_addc_co_u32 v37, vcc, 0, v37, vcc
  v_add_co_u32 v40, vcc, s28, v39
  s_nop 1
  v_addc_co_u32 v41, vcc, 0, v41, vcc
  global_load_dword v200, v[36:37], off
  global_load_dword v201, v[40:41], off
  s_lshr_b32 s28, s2, 3
  s_and_b32 s41, s28, 1
  s_lshr_b32 s28, s28, 1
  s_lshl_b32 s28, s28, 3
  s_add_u32 s40, s28, s27
  s_mov_b32 s20, 0x3e0293ee
  s_mov_b32 s43, 0xbe0293ee
  s_mov_b32 s25, 0x4b800000
  s_mov_b32 s87, 0x1000
  s_mov_b32 s88, 0x2000
  s_mov_b32 s89, 0x3000
  s_mov_b32 s21, 0
  s_mov_b32 s24, 0
  s_mov_b32 s46, 1
  s_lshl_b32 s27, s41, 8
  s_lshl_b32 s28, s26, 6
  s_add_u32 s27, s27, s28
  s_lshl_b32 s93, s27, 8
  s_sub_u32 s91, 0x1f000, s93
  v_lshlrev_b32 v27, 4, v30
  v_lshrrev_b32 v26, 4, v27
  v_and_b32 v26, 0x30, v26
  v_xor_b32 v16, v27, v26
  v_xor_b32 v17, 64, v16
  v_xor_b32 v18, 0x80, v16
  v_xor_b32 v19, 0xc0, v16
  s_lshl_b32 s90, s26, 14
  s_add_u32 s90, s90, 0x18000
  s_lshl_b32 s92, s26, 2
  s_add_u32 s92, s92, 0xa000
  s_and_b32 s27, s26, 1
  s_cmp_lt_u32 s26, 2
  s_cselect_b32 s19, 0, 0xc000
  s_mov_b32 s47, 0x2000
  s_mov_b32 s47, 0
  s_cselect_b32 s17, 0x1000000, s47
  s_cselect_b32 s18, s47, 0x1000000
  s_cselect_b32 s28, 0, 1
  s_cselect_b32 s29, 4, 8
  s_cselect_b32 s45, 15, 14
  s_lshl_b32 s47, s27, 12
  s_add_u32 s19, s19, s47
  v_lshrrev_b32 v27, 4, v30
  v_and_b32 v26, 15, v30
  v_lshlrev_b32 v25, s28, v27
  v_lshlrev_b32 v24, 8, v27
  v_add_u32 v24, s47, v24
  v_and_b32 v23, s45, v25
  v_xor_b32 v23, v26, v23
  v_lshl_add_u32 v12, v23, 4, v24
  v_add_u32 v25, s29, v25
  v_and_b32 v23, s45, v25
  v_xor_b32 v23, v26, v23
  v_lshl_add_u32 v13, v23, 4, v24
  v_add_u32 v25, s29, v25
  v_and_b32 v23, s45, v25
  v_xor_b32 v23, v26, v23
  v_lshl_add_u32 v14, v23, 4, v24
  v_add_u32 v25, s29, v25
  v_and_b32 v23, s45, v25
  v_xor_b32 v23, v26, v23
  v_lshl_add_u32 v15, v23, 4, v24
  v_add_u32 v25, s29, v25
  s_waitcnt lgkmcnt(0)
  s_mul_i32 s27, s40, 0x1f000
  s_add_u32 s27, s27, s93
  s_add_u32 s4, s32, s27
  s_addc_u32 s5, s33, 0
  s_mov_b32 s6, s91
  s_mov_b32 s7, 0x20000
  s_add_u32 s12, s38, s27
  s_addc_u32 s13, s39, 0
  s_sub_u32 s12, s12, 0xf80000
  s_subb_u32 s13, s13, 0
  s_mov_b32 s14, 0
  s_mov_b32 s15, 0x20000
  s_cmp_lt_u32 s26, 2
  s_cselect_b32 s8, s34, s36
  s_cselect_b32 s9, s35, s37
  s_lshl_b32 s27, s40, 17
  s_add_u32 s8, s8, s27
  s_addc_u32 s9, s9, 0
  s_mov_b32 s42, 0x20000
  s_mov_b32 s10, s42
  s_mov_b32 s11, 0x20000
  s_lshr_b32 s47, s2, 4
  s_and_b32 s29, s2, 7
  s_lshl_b32 s29, s29, 1
  s_add_u32 s47, s47, s29
  s_and_b32 s47, s47, 15
  s_lshl_b32 s16, s47, 13
  s_cmp_lt_u32 s26, 2
  s_cbranch_scc0 L_roleV
  s_add_u32 m0, s19, 0x0
  s_nop 0
  buffer_load_dwordx4 v12, s[8:11], s16 offen offset:0 nt lds
  buffer_load_dwordx4 v13, s[8:11], s16 offen offset:1024 nt lds
  buffer_load_dwordx4 v14, s[8:11], s16 offen offset:2048 nt lds
  buffer_load_dwordx4 v15, s[8:11], s16 offen offset:3072 nt lds
  s_add_u32 m0, s90, 0x0
  s_nop 0
  buffer_load_dwordx4 v16, s[4:7], 0 offen offset:0 nt lds
  buffer_load_dwordx4 v17, s[4:7], 0 offen offset:1024 nt lds
  buffer_load_dwordx4 v18, s[4:7], 0 offen offset:2048 nt lds
  buffer_load_dwordx4 v19, s[4:7], 0 offen offset:3072 nt lds
  s_add_u32 m0, s90, 0x1000
  s_nop 0
  buffer_load_dwordx4 v16, s[4:7], s87 offen offset:0 nt lds
  buffer_load_dwordx4 v17, s[4:7], s87 offen offset:1024 nt lds
  buffer_load_dwordx4 v18, s[4:7], s87 offen offset:2048 nt lds
  buffer_load_dwordx4 v19, s[4:7], s87 offen offset:3072 nt lds
  s_add_u32 m0, s90, 0x2000
  s_nop 0
  buffer_load_dwordx4 v16, s[4:7], s88 offen offset:0 nt lds
  buffer_load_dwordx4 v17, s[4:7], s88 offen offset:1024 nt lds
  buffer_load_dwordx4 v18, s[4:7], s88 offen offset:2048 nt lds
  buffer_load_dwordx4 v19, s[4:7], s88 offen offset:3072 nt lds
  s_add_u32 m0, s90, 0x3000
  s_nop 0
  buffer_load_dwordx4 v16, s[4:7], s89 offen offset:0 nt lds
  buffer_load_dwordx4 v17, s[4:7], s89 offen offset:1024 nt lds
  buffer_load_dwordx4 v18, s[4:7], s89 offen offset:2048 nt lds
  buffer_load_dwordx4 v19, s[4:7], s89 offen offset:3072 nt lds
  s_add_u32 s16, s16, 0x2000
  s_and_b32 s16, s16, 0x1ffff
  s_add_u32 m0, s19, 0x2000
  s_nop 0
  buffer_load_dwordx4 v12, s[8:11], s16 offen offset:0 nt lds
  buffer_load_dwordx4 v13, s[8:11], s16 offen offset:1024 nt lds
  buffer_load_dwordx4 v14, s[8:11], s16 offen offset:2048 nt lds
  buffer_load_dwordx4 v15, s[8:11], s16 offen offset:3072 nt lds
  s_add_u32 s16, s16, 0x2000
  s_and_b32 s16, s16, 0x1ffff
  s_add_u32 m0, s19, 0x4000
  s_nop 0
  buffer_load_dwordx4 v12, s[8:11], s16 offen offset:0 nt lds
  buffer_load_dwordx4 v13, s[8:11], s16 offen offset:1024 nt lds
  buffer_load_dwordx4 v14, s[8:11], s16 offen offset:2048 nt lds
  buffer_load_dwordx4 v15, s[8:11], s16 offen offset:3072 nt lds
  s_branch L_rolejoin0
L_roleV:
  s_add_u32 m0, s90, 0x0
  s_nop 0
  buffer_load_dwordx4 v16, s[4:7], 0 offen offset:0 nt lds
  buffer_load_dwordx4 v17, s[4:7], 0 offen offset:1024 nt lds
  buffer_load_dwordx4 v18, s[4:7], 0 offen offset:2048 nt lds
  buffer_load_dwordx4 v19, s[4:7], 0 offen offset:3072 nt lds
  s_add_u32 m0, s90, 0x1000
  s_nop 0
  buffer_load_dwordx4 v16, s[4:7], s87 offen offset:0 nt lds
  buffer_load_dwordx4 v17, s[4:7], s87 offen offset:1024 nt lds
  buffer_load_dwordx4 v18, s[4:7], s87 offen offset:2048 nt lds
  buffer_load_dwordx4 v19, s[4:7], s87 offen offset:3072 nt lds
  s_add_u32 m0, s90, 0x2000
  s_nop 0
  buffer_load_dwordx4 v16, s[4:7], s88 offen offset:0 nt lds
  buffer_load_dwordx4 v17, s[4:7], s88 offen offset:1024 nt lds
  buffer_load_dwordx4 v18, s[4:7], s88 offen offset:2048 nt lds
  buffer_load_dwordx4 v19, s[4:7], s88 offen offset:3072 nt lds
  s_add_u32 m0, s90, 0x3000
  s_nop 0
  buffer_load_dwordx4 v16, s[4:7], s89 offen offset:0 nt lds
  buffer_load_dwordx4 v17, s[4:7], s89 offen offset:1024 nt lds
  buffer_load_dwordx4 v18, s[4:7], s89 offen offset:2048 nt lds
  buffer_load_dwordx4 v19, s[4:7], s89 offen offset:3072 nt lds
  s_sub_u32 s16, s16, 0x2000
  s_and_b32 s16, s16, 0x1ffff
L_rolejoin0:
  s_add_u32 s16, s16, 0x2000
  s_and_b32 s16, s16, 0x1ffff
  s_add_u32 m0, s19, 0x6000
  s_nop 0
  buffer_load_dwordx4 v12, s[8:11], s16 offen offset:0 nt lds
  buffer_load_dwordx4 v13, s[8:11], s16 offen offset:1024 nt lds
  buffer_load_dwordx4 v14, s[8:11], s16 offen offset:2048 nt lds
  buffer_load_dwordx4 v15, s[8:11], s16 offen offset:3072 nt lds
  s_add_u32 s16, s16, 0x2000
  s_and_b32 s16, s16, 0x1ffff
  s_add_u32 m0, s19, 0x8000
  s_nop 0
  buffer_load_dwordx4 v12, s[8:11], s16 offen offset:0 nt lds
  buffer_load_dwordx4 v13, s[8:11], s16 offen offset:1024 nt lds
  buffer_load_dwordx4 v14, s[8:11], s16 offen offset:2048 nt lds
  buffer_load_dwordx4 v15, s[8:11], s16 offen offset:3072 nt lds
  v_and_b32 v27, 15, v30
  v_lshrrev_b32 v26, 4, v30
  v_xor_b32 v25, v26, v27
  v_lshlrev_b32 v24, 8, v27
  v_lshl_add_u32 v0, v25, 4, v24
  v_xor_b32 v1, 64, v0
  v_xor_b32 v2, 128, v0
  v_xor_b32 v3, 192, v0
  v_lshrrev_b32 v25, 1, v26
  v_xor_b32 v25, v25, v27
  v_lshl_add_u32 v25, v25, 4, v24
  v_and_b32 v23, 1, v26
  v_lshl_add_u32 v25, v23, 3, v25
  v_add_u32 v28, s90, v25
  v_bfe_u32 v25, v30, 2, 2
  v_lshl_add_u32 v25, v26, 2, v25
  v_and_b32 v24, 7, v25
  v_lshlrev_b32 v25, 8, v25
  v_lshl_add_u32 v25, v24, 5, v25
  v_and_b32 v24, 3, v30
  v_lshl_add_u32 v25, v24, 3, v25
  v_add_u32 v4, 0xc000, v25
  v_xor_b32 v5, 32, v4
  v_xor_b32 v6, 64, v4
  v_xor_b32 v7, 96, v4
  v_xor_b32 v8, 128, v4
  v_xor_b32 v9, 160, v4
  v_xor_b32 v10, 192, v4
  v_xor_b32 v11, 224, v4
  v_and_b32 v27, 3, v27
  v_mov_b32 v26, 0
  v_mov_b32 v25, 0x3f803f80
  v_cmp_eq_u32 vcc, 0, v27
  s_nop 1
  v_cndmask_b32 v24, v26, v25, vcc
  s_nop 1
  v_accvgpr_write_b32 a100, v24
  v_accvgpr_write_b32 a101, v24
  v_accvgpr_write_b32 a102, v24
  v_accvgpr_write_b32 a103, v24
  v_cmp_eq_u32 vcc, 1, v27
  s_nop 1
  v_cndmask_b32 v24, v26, v25, vcc
  s_nop 1
  v_accvgpr_write_b32 a104, v24
  v_accvgpr_write_b32 a105, v24
  v_accvgpr_write_b32 a106, v24
  v_accvgpr_write_b32 a107, v24
  v_cmp_eq_u32 vcc, 2, v27
  s_nop 1
  v_cndmask_b32 v24, v26, v25, vcc
  s_nop 1
  v_accvgpr_write_b32 a108, v24
  v_accvgpr_write_b32 a109, v24
  v_accvgpr_write_b32 a110, v24
  v_accvgpr_write_b32 a111, v24
  v_cmp_eq_u32 vcc, 3, v27
  s_nop 1
  v_cndmask_b32 v24, v26, v25, vcc
  s_nop 1
  v_accvgpr_write_b32 a112, v24
  v_accvgpr_write_b32 a113, v24
  v_accvgpr_write_b32 a114, v24
  v_accvgpr_write_b32 a115, v24
  v_lshlrev_b32 v27, 4, v30
  v_add_u32 v29, s90, v27
  s_add_u32 s4, s4, 0xf80000
  s_addc_u32 s5, s5, 0
  s_cmp_lt_u32 s26, 2
  s_cbranch_scc0 L_roleV2
  s_waitcnt vmcnt(12)
  s_branch L_rolejoin1
L_roleV2:
  s_waitcnt vmcnt(8)
L_rolejoin1:
  s_barrier
  ds_read_b128 a[128:131], v0 offset:0
  v_add_u32 v30, s90, v0
  ds_read_b128 a[0:3], v30 offset:0
  ds_read_b128 a[16:19], v30 offset:4096
  ds_read_b128 a[32:35], v30 offset:8192
  ds_read_b128 a[48:51], v30 offset:12288
  ds_read_b128 a[132:135], v1 offset:0
  v_add_u32 v31, s90, v1
  ds_read_b128 a[4:7], v31 offset:0
  ds_read_b128 a[20:23], v31 offset:4096
  ds_read_b128 a[36:39], v31 offset:8192
  ds_read_b128 a[52:55], v31 offset:12288
  ds_read_b128 a[136:139], v2 offset:0
  v_add_u32 v30, s90, v2
  ds_read_b128 a[8:11], v30 offset:0
  ds_read_b128 a[24:27], v30 offset:4096
  ds_read_b128 a[40:43], v30 offset:8192
  ds_read_b128 a[56:59], v30 offset:12288
  ds_read_b128 a[140:143], v3 offset:0
  v_add_u32 v31, s90, v3
  ds_read_b128 a[12:15], v31 offset:0
  ds_read_b128 a[28:31], v31 offset:4096
  ds_read_b128 a[44:47], v31 offset:8192
  ds_read_b128 a[60:63], v31 offset:12288
  ds_read_b128 a[144:147], v0 offset:4096
  ds_read_b128 a[148:151], v1 offset:4096
  ds_read_b128 a[152:155], v2 offset:4096
  ds_read_b128 a[156:159], v3 offset:4096
  s_waitcnt lgkmcnt(15)
  v_mfma_f32_16x16x32_bf16 v[32:35], a[128:131], a[0:3], 0
  ds_read_b128 a[64:67], v0 offset:8192
  s_waitcnt lgkmcnt(15)
  v_mfma_f32_16x16x32_bf16 v[32:35], a[132:135], a[4:7], v[32:35]
  s_waitcnt lgkmcnt(13)
  v_mfma_f32_16x16x32_bf16 v[32:35], a[136:139], a[8:11], v[32:35]
  ds_read_b128 a[68:71], v1 offset:8192
  s_waitcnt lgkmcnt(9)
  v_mfma_f32_16x16x32_bf16 v[32:35], a[140:143], a[12:15], v[32:35]
  s_waitcnt lgkmcnt(5)
  v_mfma_f32_16x16x32_bf16 v[48:51], a[144:147], a[0:3], 0
  ds_read_b128 a[72:75], v2 offset:8192
  s_waitcnt lgkmcnt(5)
  v_mfma_f32_16x16x32_bf16 v[48:51], a[148:151], a[4:7], v[48:51]
  s_waitcnt lgkmcnt(4)
  v_mfma_f32_16x16x32_bf16 v[48:51], a[152:155], a[8:11], v[48:51]
  ds_read_b128 a[76:79], v3 offset:8192
  v_max3_f32 v24, v32, v33, v34
  s_waitcnt lgkmcnt(4)
  v_mfma_f32_16x16x32_bf16 v[48:51], a[156:159], a[12:15], v[48:51]
  v_mfma_f32_16x16x32_bf16 v[36:39], a[128:131], a[16:19], 0
  ds_read_b128 a[80:83], v0 offset:12288
  v_mfma_f32_16x16x32_bf16 v[36:39], a[132:135], a[20:23], v[36:39]
  v_mfma_f32_16x16x32_bf16 v[36:39], a[136:139], a[24:27], v[36:39]
  ds_read_b128 a[84:87], v1 offset:12288
  v_mfma_f32_16x16x32_bf16 v[36:39], a[140:143], a[28:31], v[36:39]
  v_mfma_f32_16x16x32_bf16 v[52:55], a[144:147], a[16:19], 0
  ds_read_b128 a[88:91], v2 offset:12288
  v_max3_f32 v24, v24, v35, v48
  v_mfma_f32_16x16x32_bf16 v[52:55], a[148:151], a[20:23], v[52:55]
  v_max3_f32 v24, v24, v49, v50
  v_max_f32 v24, v24, v51
  v_mfma_f32_16x16x32_bf16 v[52:55], a[152:155], a[24:27], v[52:55]
  ds_read_b128 a[92:95], v3 offset:12288
  v_mov_b32 v30, v24
  v_mfma_f32_16x16x32_bf16 v[52:55], a[156:159], a[28:31], v[52:55]
  v_max3_f32 v25, v36, v37, v38
  v_permlane16_swap_b32 v30, v24
  v_mfma_f32_16x16x32_bf16 v[40:43], a[128:131], a[32:35], 0
  v_max_f32 v24, v24, v30
  v_mov_b32 v30, v24
  v_mfma_f32_16x16x32_bf16 v[40:43], a[132:135], a[36:39], v[40:43]
  v_mfma_f32_16x16x32_bf16 v[40:43], a[136:139], a[40:43], v[40:43]
  v_permlane32_swap_b32 v30, v24
  v_max3_f32 v25, v25, v39, v52
  v_max_f32 v24, v24, v30
  v_mfma_f32_16x16x32_bf16 v[40:43], a[140:143], a[44:47], v[40:43]
  v_mul_f32 v20, s43, v24
  v_max3_f32 v25, v25, v53, v54
  v_fma_f32 v32, v32, s20, v20
  v_mfma_f32_16x16x32_bf16 v[56:59], a[144:147], a[32:35], 0
  v_exp_f32 v32, v32
  v_fma_f32 v33, v33, s20, v20
  v_mfma_f32_16x16x32_bf16 v[56:59], a[148:151], a[36:39], v[56:59]
  v_exp_f32 v33, v33
  v_fma_f32 v34, v34, s20, v20
  v_mfma_f32_16x16x32_bf16 v[56:59], a[152:155], a[40:43], v[56:59]
  v_exp_f32 v34, v34
  v_cvt_pk_bf16_f32 v96, v32, v33
  v_mfma_f32_16x16x32_bf16 v[56:59], a[156:159], a[44:47], v[56:59]
  v_fma_f32 v35, v35, s20, v20
  v_fma_f32 v48, v48, s20, v20
  v_mfma_f32_16x16x32_bf16 v[44:47], a[128:131], a[48:51], 0
  v_exp_f32 v35, v35
  v_fma_f32 v49, v49, s20, v20
  v_mfma_f32_16x16x32_bf16 v[44:47], a[132:135], a[52:55], v[44:47]
  v_cvt_pk_bf16_f32 v97, v34, v35
  v_exp_f32 v48, v48
  v_mfma_f32_16x16x32_bf16 v[44:47], a[136:139], a[56:59], v[44:47]
  v_exp_f32 v49, v49
  v_fma_f32 v50, v50, s20, v20
  v_mfma_f32_16x16x32_bf16 v[44:47], a[140:143], a[60:63], v[44:47]
  v_exp_f32 v50, v50
  v_cvt_pk_bf16_f32 v98, v48, v49
  v_mfma_f32_16x16x32_bf16 v[60:63], a[144:147], a[48:51], 0
  v_fma_f32 v51, v51, s20, v20
  v_max_f32 v25, v25, v55
  v_max3_f32 v26, v40, v41, v42
  v_mfma_f32_16x16x32_bf16 v[60:63], a[148:151], a[52:55], v[60:63]
  v_exp_f32 v51, v51
  v_mov_b32 v31, v25
  v_mfma_f32_16x16x32_bf16 v[60:63], a[152:155], a[56:59], v[60:63]
  v_cvt_pk_bf16_f32 v99, v50, v51
  v_permlane16_swap_b32 v31, v25
  v_max3_f32 v26, v26, v43, v56
  v_mfma_f32_16x16x32_bf16 v[60:63], a[156:159], a[60:63], v[60:63]
  s_waitcnt vmcnt(8) lgkmcnt(0)
  s_barrier
  v_mfma_f32_16x16x32_bf16 v[64:67], a[64:67], a[0:3], 0
  s_add_u32 s16, s16, 0x2000
  s_and_b32 s16, s16, 0x1ffff
  s_add_u32 m0, s19, 0x0
  v_mfma_f32_16x16x32_bf16 v[64:67], a[68:71], a[4:7], v[64:67]
  ds_read_b128 a[128:131], v0 offset:16384
  v_max_f32 v25, v25, v31
  v_max3_f32 v26, v26, v57, v58
  v_mfma_f32_16x16x32_bf16 v[64:67], a[72:75], a[8:11], v[64:67]
  buffer_load_dwordx4 v12, s[8:11], s16 offen offset:0 nt lds
  v_mfma_f32_16x16x32_bf16 v[64:67], a[76:79], a[12:15], v[64:67]
  ds_read_b128 a[132:135], v1 offset:16384
  v_mov_b32 v31, v25
  v_max_f32 v26, v26, v59
  v_mfma_f32_16x16x32_bf16 v[80:83], a[80:83], a[0:3], 0
  buffer_load_dwordx4 v13, s[8:11], s16 offen offset:1024 nt lds
  v_permlane32_swap_b32 v31, v25
  v_mfma_f32_16x16x32_bf16 v[80:83], a[84:87], a[4:7], v[80:83]
  ds_read_b128 a[136:139], v2 offset:16384
  v_max_f32 v25, v25, v31
  v_mov_b32 v30, v26
  v_mfma_f32_16x16x32_bf16 v[80:83], a[88:91], a[8:11], v[80:83]
  buffer_load_dwordx4 v14, s[8:11], s16 offen offset:2048 nt lds
  v_mul_f32 v21, s43, v25
  v_mfma_f32_16x16x32_bf16 v[80:83], a[92:95], a[12:15], v[80:83]
  ds_read_b128 a[140:143], v3 offset:16384
  v_fma_f32 v36, v36, s20, v21
  v_fma_f32 v37, v37, s20, v21
  v_mfma_f32_16x16x32_bf16 v[68:71], a[64:67], a[16:19], 0
  buffer_load_dwordx4 v15, s[8:11], s16 offen offset:3072 nt lds
  v_mfma_f32_16x16x32_bf16 v[68:71], a[68:71], a[20:23], v[68:71]
  ds_read_b128 a[144:147], v0 offset:20480
  v_exp_f32 v36, v36
  v_mfma_f32_16x16x32_bf16 v[68:71], a[72:75], a[24:27], v[68:71]
  v_exp_f32 v37, v37
  v_fma_f32 v38, v38, s20, v21
  v_mfma_f32_16x16x32_bf16 v[68:71], a[76:79], a[28:31], v[68:71]
  ds_read_b128 a[148:151], v1 offset:20480
  v_exp_f32 v38, v38
  v_mfma_f32_16x16x32_bf16 v[84:87], a[80:83], a[16:19], 0
  v_cvt_pk_bf16_f32 v100, v36, v37
  v_fma_f32 v39, v39, s20, v21
  v_fma_f32 v52, v52, s20, v21
  v_mfma_f32_16x16x32_bf16 v[84:87], a[84:87], a[20:23], v[84:87]
  ds_read_b128 a[152:155], v2 offset:20480
  v_exp_f32 v39, v39
  v_mfma_f32_16x16x32_bf16 v[84:87], a[88:91], a[24:27], v[84:87]
  v_exp_f32 v52, v52
  v_cvt_pk_bf16_f32 v101, v38, v39
  v_mfma_f32_16x16x32_bf16 v[84:87], a[92:95], a[28:31], v[84:87]
  ds_read_b128 a[156:159], v3 offset:20480
  v_fma_f32 v53, v53, s20, v21
  v_mfma_f32_16x16x32_bf16 v[72:75], a[64:67], a[32:35], 0
  s_add_u32 s16, s16, 0x2000
  s_and_b32 s16, s16, 0x1ffff
  s_add_u32 m0, s19, 0x2000
  v_mfma_f32_16x16x32_bf16 v[72:75], a[68:71], a[36:39], v[72:75]
  v_exp_f32 v53, v53
  v_fma_f32 v54, v54, s20, v21
  v_mfma_f32_16x16x32_bf16 v[72:75], a[72:75], a[40:43], v[72:75]
  buffer_load_dwordx4 v12, s[8:11], s16 offen offset:0 nt lds
  v_cvt_pk_bf16_f32 v102, v52, v53
  v_mfma_f32_16x16x32_bf16 v[72:75], a[76:79], a[44:47], v[72:75]
  v_exp_f32 v54, v54
  v_fma_f32 v55, v55, s20, v21
  v_mfma_f32_16x16x32_bf16 v[88:91], a[80:83], a[32:35], 0
  buffer_load_dwordx4 v13, s[8:11], s16 offen offset:1024 nt lds
  v_permlane16_swap_b32 v30, v26
  v_mfma_f32_16x16x32_bf16 v[88:91], a[84:87], a[36:39], v[88:91]
  v_exp_f32 v55, v55
  v_max_f32 v26, v26, v30
  v_mfma_f32_16x16x32_bf16 v[88:91], a[88:91], a[40:43], v[88:91]
  buffer_load_dwordx4 v14, s[8:11], s16 offen offset:2048 nt lds
  v_cvt_pk_bf16_f32 v103, v54, v55
  v_mfma_f32_16x16x32_bf16 v[88:91], a[92:95], a[44:47], v[88:91]
  v_mov_b32 v30, v26
  v_max3_f32 v27, v44, v45, v46
  v_fma_f32 v64, v64, s20, v20
  v_mfma_f32_16x16x32_bf16 v[76:79], a[64:67], a[48:51], 0
  buffer_load_dwordx4 v15, s[8:11], s16 offen offset:3072 nt lds
  v_permlane32_swap_b32 v30, v26
  v_max3_f32 v27, v27, v47, v60
  v_mfma_f32_16x16x32_bf16 v[76:79], a[68:71], a[52:55], v[76:79]
  v_max_f32 v26, v26, v30
  v_max3_f32 v27, v27, v61, v62
  v_mul_f32 v22, s43, v26
  v_mfma_f32_16x16x32_bf16 v[76:79], a[72:75], a[56:59], v[76:79]
  v_fma_f32 v40, v40, s20, v22
  v_fma_f32 v41, v41, s20, v22
  v_fma_f32 v42, v42, s20, v22
  v_mfma_f32_16x16x32_bf16 v[76:79], a[76:79], a[60:63], v[76:79]
  v_exp_f32 v40, v40
  v_fma_f32 v43, v43, s20, v22
  v_mfma_f32_16x16x32_bf16 v[92:95], a[80:83], a[48:51], 0
  v_exp_f32 v41, v41
  v_fma_f32 v56, v56, s20, v22
  v_mfma_f32_16x16x32_bf16 v[92:95], a[84:87], a[52:55], v[92:95]
  v_exp_f32 v42, v42
  v_cvt_pk_bf16_f32 v104, v40, v41
  v_mfma_f32_16x16x32_bf16 v[92:95], a[88:91], a[56:59], v[92:95]
  v_exp_f32 v43, v43
  v_fma_f32 v57, v57, s20, v22
  v_mfma_f32_16x16x32_bf16 v[92:95], a[92:95], a[60:63], v[92:95]
  s_waitcnt vmcnt(12) lgkmcnt(0)
  s_barrier
  v_mfma_f32_16x16x32_bf16 v[32:35], a[128:131], a[0:3], 0
  ds_read_b64_tr_b16 a[160:161], v4 offset:24576
  v_cvt_pk_bf16_f32 v105, v42, v43
  v_fma_f32 v58, v58, s20, v22
  v_mfma_f32_16x16x32_bf16 v[32:35], a[132:135], a[4:7], v[32:35]
  v_exp_f32 v56, v56
  v_exp_f32 v57, v57
  v_mfma_f32_16x16x32_bf16 v[32:35], a[136:139], a[8:11], v[32:35]
  ds_read_b64_tr_b16 a[162:163], v4 offset:28672
  v_exp_f32 v58, v58
  v_mfma_f32_16x16x32_bf16 v[32:35], a[140:143], a[12:15], v[32:35]
  v_cvt_pk_bf16_f32 v106, v56, v57
  s_add_u32 s16, s16, 0x2000
  s_and_b32 s16, s16, 0x1ffff
  v_mfma_f32_16x16x32_bf16 v[48:51], a[144:147], a[0:3], 0
  ds_read_b64_tr_b16 a[164:165], v5 offset:24576
  v_fma_f32 v59, v59, s20, v22
  v_max_f32 v27, v27, v63
  v_mfma_f32_16x16x32_bf16 v[48:51], a[148:151], a[4:7], v[48:51]
  v_exp_f32 v59, v59
  s_add_u32 m0, s19, 0x4000
  v_mfma_f32_16x16x32_bf16 v[48:51], a[152:155], a[8:11], v[48:51]
  ds_read_b64_tr_b16 a[166:167], v5 offset:28672
  v_cvt_pk_bf16_f32 v107, v58, v59
  v_mov_b32 v31, v27
  v_mfma_f32_16x16x32_bf16 v[48:51], a[156:159], a[12:15], v[48:51]
  buffer_load_dwordx4 v12, s[8:11], s16 offen offset:0 nt lds
  v_permlane16_swap_b32 v31, v27
  v_mfma_f32_16x16x32_bf16 v[36:39], a[128:131], a[16:19], 0
  ds_read_b64_tr_b16 a[168:169], v6 offset:24576
  v_max_f32 v27, v27, v31
  v_fma_f32 v65, v65, s20, v20
  v_mfma_f32_16x16x32_bf16 v[36:39], a[132:135], a[20:23], v[36:39]
  v_mov_b32 v31, v27
  v_exp_f32 v64, v64
  v_mfma_f32_16x16x32_bf16 v[36:39], a[136:139], a[24:27], v[36:39]
  ds_read_b64_tr_b16 a[170:171], v6 offset:28672
  v_permlane32_swap_b32 v31, v27
  v_fma_f32 v66, v66, s20, v20
  v_mfma_f32_16x16x32_bf16 v[36:39], a[140:143], a[28:31], v[36:39]
  buffer_load_dwordx4 v13, s[8:11], s16 offen offset:1024 nt lds
  v_max_f32 v27, v27, v31
  v_mfma_f32_16x16x32_bf16 v[52:55], a[144:147], a[16:19], 0
  ds_read_b64_tr_b16 a[172:173], v7 offset:24576
  v_mul_f32 v23, s43, v27
  v_fma_f32 v67, v67, s20, v20
  v_mfma_f32_16x16x32_bf16 v[52:55], a[148:151], a[20:23], v[52:55]
  v_fma_f32 v44, v44, s20, v23
  v_fma_f32 v45, v45, s20, v23
  v_fma_f32 v46, v46, s20, v23
  v_mfma_f32_16x16x32_bf16 v[52:55], a[152:155], a[24:27], v[52:55]
  ds_read_b64_tr_b16 a[174:175], v7 offset:28672
  v_exp_f32 v44, v44
  v_mfma_f32_16x16x32_bf16 v[52:55], a[156:159], a[28:31], v[52:55]
  buffer_load_dwordx4 v14, s[8:11], s16 offen offset:2048 nt lds
  v_exp_f32 v45, v45
  v_mfma_f32_16x16x32_bf16 v[40:43], a[128:131], a[32:35], 0
  ds_read_b64_tr_b16 a[176:177], v8 offset:24576
  v_exp_f32 v46, v46
  v_mfma_f32_16x16x32_bf16 v[40:43], a[132:135], a[36:39], v[40:43]
  v_cvt_pk_bf16_f32 v108, v44, v45
  v_fma_f32 v47, v47, s20, v23
  v_fma_f32 v60, v60, s20, v23
  v_mfma_f32_16x16x32_bf16 v[40:43], a[136:139], a[40:43], v[40:43]
  ds_read_b64_tr_b16 a[178:179], v8 offset:28672
  v_exp_f32 v47, v47
  v_mfma_f32_16x16x32_bf16 v[40:43], a[140:143], a[44:47], v[40:43]
  buffer_load_dwordx4 v15, s[8:11], s16 offen offset:3072 nt lds
  v_cvt_pk_bf16_f32 v109, v46, v47
  v_mfma_f32_16x16x32_bf16 v[56:59], a[144:147], a[32:35], 0
  ds_read_b64_tr_b16 a[180:181], v9 offset:24576
  v_exp_f32 v60, v60
  v_mfma_f32_16x16x32_bf16 v[56:59], a[148:151], a[36:39], v[56:59]
  v_fma_f32 v61, v61, s20, v23
  v_fma_f32 v62, v62, s20, v23
  v_fma_f32 v63, v63, s20, v23
  v_mfma_f32_16x16x32_bf16 v[56:59], a[152:155], a[40:43], v[56:59]
  ds_read_b64_tr_b16 a[182:183], v9 offset:28672
  v_exp_f32 v61, v61
  v_mfma_f32_16x16x32_bf16 v[56:59], a[156:159], a[44:47], v[56:59]
  v_exp_f32 v62, v62
  v_cvt_pk_bf16_f32 v110, v60, v61
  v_mfma_f32_16x16x32_bf16 v[44:47], a[128:131], a[48:51], 0
  ds_read_b64_tr_b16 a[184:185], v10 offset:24576
  v_exp_f32 v63, v63
  v_mfma_f32_16x16x32_bf16 v[44:47], a[132:135], a[52:55], v[44:47]
  v_exp_f32 v65, v65
  v_cvt_pk_bf16_f32 v111, v62, v63
  v_mfma_f32_16x16x32_bf16 v[44:47], a[136:139], a[56:59], v[44:47]
  ds_read_b64_tr_b16 a[186:187], v10 offset:28672
  v_exp_f32 v66, v66
  v_mfma_f32_16x16x32_bf16 v[44:47], a[140:143], a[60:63], v[44:47]
  v_exp_f32 v67, v67
  v_cvt_pk_bf16_f32 v112, v64, v65
  v_mfma_f32_16x16x32_bf16 v[60:63], a[144:147], a[48:51], 0
  ds_read_b64_tr_b16 a[188:189], v11 offset:24576
  v_cvt_pk_bf16_f32 v113, v66, v67
  v_fma_f32 v80, v80, s20, v20
  v_mfma_f32_16x16x32_bf16 v[60:63], a[148:151], a[52:55], v[60:63]
  v_exp_f32 v80, v80
  v_fma_f32 v81, v81, s20, v20
  v_mfma_f32_16x16x32_bf16 v[60:63], a[152:155], a[56:59], v[60:63]
  ds_read_b64_tr_b16 a[190:191], v11 offset:28672
  v_exp_f32 v81, v81
  v_fma_f32 v82, v82, s20, v20
  v_mfma_f32_16x16x32_bf16 v[60:63], a[156:159], a[60:63], v[60:63]
  v_exp_f32 v82, v82
  v_cvt_pk_bf16_f32 v114, v80, v81
  v_mfma_f32_16x16x32_bf16 a[96:99], a[100:103], v[96:99], 0
  v_fma_f32 v83, v83, s20, v20
  v_fma_f32 v68, v68, s20, v21
  v_fma_f32 v69, v69, s20, v21
  v_mfma_f32_16x16x32_bf16 a[96:99], a[104:107], v[100:103], a[96:99]
  v_exp_f32 v83, v83
  v_fma_f32 v70, v70, s20, v21
  v_mfma_f32_16x16x32_bf16 a[96:99], a[108:111], v[104:107], a[96:99]
  v_exp_f32 v68, v68
  v_cvt_pk_bf16_f32 v115, v82, v83
  v_mfma_f32_16x16x32_bf16 a[96:99], a[112:115], v[108:111], a[96:99]
  v_exp_f32 v69, v69
  s_waitcnt lgkmcnt(1)
  v_mfma_f32_16x16x32_bf16 v[128:131], a[160:163], v[96:99], 0
  ds_read_b128 a[128:131], v0 offset:24576
  v_exp_f32 v70, v70
  v_mfma_f32_16x16x32_bf16 v[160:163], a[160:163], v[100:103], 0
  v_cvt_pk_bf16_f32 v116, v68, v69
  v_fma_f32 v71, v71, s20, v21
  v_fma_f32 v84, v84, s20, v21
  v_mfma_f32_16x16x32_bf16 v[132:135], a[164:167], v[96:99], 0
  ds_read_b128 a[132:135], v1 offset:24576
  v_exp_f32 v71, v71
  v_mfma_f32_16x16x32_bf16 v[164:167], a[164:167], v[100:103], 0
  v_exp_f32 v84, v84
  v_cvt_pk_bf16_f32 v117, v70, v71
  v_mfma_f32_16x16x32_bf16 v[136:139], a[168:171], v[96:99], 0
  ds_read_b128 a[136:139], v2 offset:24576
  v_fma_f32 v85, v85, s20, v21
  v_fma_f32 v86, v86, s20, v21
  v_mfma_f32_16x16x32_bf16 v[168:171], a[168:171], v[100:103], 0
  v_exp_f32 v85, v85
  v_fma_f32 v87, v87, s20, v21
  v_mfma_f32_16x16x32_bf16 v[140:143], a[172:175], v[96:99], 0
  ds_read_b128 a[140:143], v3 offset:24576
  v_exp_f32 v86, v86
  v_mfma_f32_16x16x32_bf16 v[172:175], a[172:175], v[100:103], 0
  v_exp_f32 v87, v87
  v_cvt_pk_bf16_f32 v118, v84, v85
  v_mfma_f32_16x16x32_bf16 v[144:147], a[176:179], v[96:99], 0
  ds_read_b128 a[144:147], v0 offset:28672
  v_cvt_pk_bf16_f32 v119, v86, v87
  v_fma_f32 v72, v72, s20, v22
  v_mfma_f32_16x16x32_bf16 v[176:179], a[176:179], v[100:103], 0
  v_exp_f32 v72, v72
  v_fma_f32 v73, v73, s20, v22
  v_fma_f32 v74, v74, s20, v22
  v_mfma_f32_16x16x32_bf16 v[148:151], a[180:183], v[96:99], 0
  ds_read_b128 a[148:151], v1 offset:28672
  v_exp_f32 v73, v73
  v_mfma_f32_16x16x32_bf16 v[180:183], a[180:183], v[100:103], 0
  v_exp_f32 v74, v74
  v_cvt_pk_bf16_f32 v120, v72, v73
  v_mfma_f32_16x16x32_bf16 v[152:155], a[184:187], v[96:99], 0
  ds_read_b128 a[152:155], v2 offset:28672
  v_fma_f32 v75, v75, s20, v22
  v_fma_f32 v88, v88, s20, v22
  v_mfma_f32_16x16x32_bf16 v[184:187], a[184:187], v[100:103], 0
  v_exp_f32 v75, v75
  s_waitcnt lgkmcnt(3)
  v_mfma_f32_16x16x32_bf16 v[156:159], a[188:191], v[96:99], 0
  ds_read_b128 a[156:159], v3 offset:28672
  v_exp_f32 v88, v88
  v_mfma_f32_16x16x32_bf16 v[188:191], a[188:191], v[100:103], 0
  v_cvt_pk_bf16_f32 v121, v74, v75
  v_fma_f32 v89, v89, s20, v22
  v_fma_f32 v90, v90, s20, v22
  v_mfma_f32_16x16x32_bf16 v[192:195], a[160:163], v[104:107], 0
  v_exp_f32 v89, v89
  v_fma_f32 v91, v91, s20, v22
  v_mfma_f32_16x16x32_bf16 v[224:227], a[160:163], v[108:111], 0
  v_exp_f32 v90, v90
  v_cvt_pk_bf16_f32 v122, v88, v89
  v_mfma_f32_16x16x32_bf16 v[196:199], a[164:167], v[104:107], 0
  v_exp_f32 v91, v91
  v_fma_f32 v76, v76, s20, v23
  v_mfma_f32_16x16x32_bf16 v[228:231], a[164:167], v[108:111], 0
  s_cmp_eq_u32 s21, 3
  s_cselect_b32 s23, 0, s42
  s_cselect_b32 s6, 0, s91
  v_mfma_f32_16x16x32_bf16 v[200:203], a[168:171], v[104:107], 0
  v_exp_f32 v76, v76
  v_cvt_pk_bf16_f32 v123, v90, v91
  v_mfma_f32_16x16x32_bf16 v[232:235], a[168:171], v[108:111], 0
  v_fma_f32 v77, v77, s20, v23
  s_cmp_lt_u32 s26, 2
  s_cselect_b32 s22, s23, s42
  v_mfma_f32_16x16x32_bf16 v[204:207], a[172:175], v[104:107], 0
  v_exp_f32 v77, v77
  v_fma_f32 v78, v78, s20, v23
  v_mfma_f32_16x16x32_bf16 v[236:239], a[172:175], v[108:111], 0
  v_exp_f32 v78, v78
  v_cvt_pk_bf16_f32 v124, v76, v77
  v_fma_f32 v79, v79, s20, v23
  v_mfma_f32_16x16x32_bf16 v[208:211], a[176:179], v[104:107], 0
  v_exp_f32 v79, v79
  v_fma_f32 v92, v92, s20, v23
  v_mfma_f32_16x16x32_bf16 v[240:243], a[176:179], v[108:111], 0
  v_exp_f32 v92, v92
  v_cvt_pk_bf16_f32 v125, v78, v79
  v_mfma_f32_16x16x32_bf16 v[212:215], a[180:183], v[104:107], 0
  v_fma_f32 v93, v93, s20, v23
  v_fma_f32 v94, v94, s20, v23
  v_fma_f32 v95, v95, s20, v23
  v_mfma_f32_16x16x32_bf16 v[244:247], a[180:183], v[108:111], 0
  v_exp_f32 v93, v93
  v_mfma_f32_16x16x32_bf16 v[216:219], a[184:187], v[104:107], 0
  v_exp_f32 v94, v94
  v_cvt_pk_bf16_f32 v126, v92, v93
  v_mfma_f32_16x16x32_bf16 v[248:251], a[184:187], v[108:111], 0
  v_exp_f32 v95, v95
  v_mfma_f32_16x16x32_bf16 v[220:223], a[188:191], v[104:107], 0
  v_mfma_f32_16x16x32_bf16 v[252:255], a[188:191], v[108:111], 0
  s_waitcnt vmcnt(12) lgkmcnt(0)
  s_barrier
  v_cvt_pk_bf16_f32 v127, v94, v95
.p2align 6
L_loop:
  v_mfma_f32_16x16x32_bf16 v[64:67], a[128:131], a[0:3], 0
  ds_read_b64_tr_b16 a[160:161], v4 offset:32768
  v_fma_f32 v32, v32, s20, v20
  v_mfma_f32_16x16x32_bf16 v[64:67], a[132:135], a[4:7], v[64:67]
  v_exp_f32 v32, v32
  v_mfma_f32_16x16x32_bf16 v[64:67], a[136:139], a[8:11], v[64:67]
  ds_read_b64_tr_b16 a[162:163], v4 offset:36864
  v_fma_f32 v33, v33, s20, v20
  v_mfma_f32_16x16x32_bf16 v[64:67], a[140:143], a[12:15], v[64:67]
  s_add_u32 s16, s16, 0x2000
  s_and_b32 s16, s16, 0x1ffff
  v_mfma_f32_16x16x32_bf16 v[80:83], a[144:147], a[0:3], 0
  ds_read_b64_tr_b16 a[164:165], v5 offset:32768
  v_fma_f32 v34, v34, s20, v20
  v_mfma_f32_16x16x32_bf16 v[80:83], a[148:151], a[4:7], v[80:83]
  v_fma_f32 v35, v35, s20, v20
  s_add_u32 m0, s19, 0x6000
  v_mfma_f32_16x16x32_bf16 v[80:83], a[152:155], a[8:11], v[80:83]
  ds_read_b64_tr_b16 a[166:167], v5 offset:36864
  v_fma_f32 v48, v48, s20, v20
  v_mfma_f32_16x16x32_bf16 v[80:83], a[156:159], a[12:15], v[80:83]
  buffer_load_dwordx4 v12, s[8:11], s16 offen offset:0 nt lds
  v_mfma_f32_16x16x32_bf16 v[68:71], a[128:131], a[16:19], 0
  ds_read_b64_tr_b16 a[168:169], v6 offset:32768
  v_fma_f32 v49, v49, s20, v20
  v_mfma_f32_16x16x32_bf16 v[68:71], a[132:135], a[20:23], v[68:71]
  v_exp_f32 v33, v33
  v_mfma_f32_16x16x32_bf16 v[68:71], a[136:139], a[24:27], v[68:71]
  ds_read_b64_tr_b16 a[170:171], v6 offset:36864
  v_cvt_pk_bf16_f32 v96, v32, v33
  v_mfma_f32_16x16x32_bf16 v[68:71], a[140:143], a[28:31], v[68:71]
  buffer_load_dwordx4 v13, s[8:11], s16 offen offset:1024 nt lds
  v_mfma_f32_16x16x32_bf16 v[84:87], a[144:147], a[16:19], 0
  ds_read_b64_tr_b16 a[172:173], v7 offset:32768
  v_fma_f32 v50, v50, s20, v20
  v_mfma_f32_16x16x32_bf16 v[84:87], a[148:151], a[20:23], v[84:87]
  v_exp_f32 v34, v34
  v_mfma_f32_16x16x32_bf16 v[84:87], a[152:155], a[24:27], v[84:87]
  ds_read_b64_tr_b16 a[174:175], v7 offset:36864
  v_fma_f32 v51, v51, s20, v20
  v_mfma_f32_16x16x32_bf16 v[84:87], a[156:159], a[28:31], v[84:87]
  buffer_load_dwordx4 v14, s[8:11], s16 offen offset:2048 nt lds
  v_mfma_f32_16x16x32_bf16 v[72:75], a[128:131], a[32:35], 0
  ds_read_b64_tr_b16 a[176:177], v8 offset:32768
  v_fma_f32 v36, v36, s20, v21
  v_mfma_f32_16x16x32_bf16 v[72:75], a[132:135], a[36:39], v[72:75]
  v_exp_f32 v35, v35
  v_mfma_f32_16x16x32_bf16 v[72:75], a[136:139], a[40:43], v[72:75]
  ds_read_b64_tr_b16 a[178:179], v8 offset:36864
  v_cvt_pk_bf16_f32 v97, v34, v35
  v_mfma_f32_16x16x32_bf16 v[72:75], a[140:143], a[44:47], v[72:75]
  buffer_load_dwordx4 v15, s[8:11], s16 offen offset:3072 nt lds
  v_mfma_f32_16x16x32_bf16 v[88:91], a[144:147], a[32:35], 0
  ds_read_b64_tr_b16 a[180:181], v9 offset:32768
  v_fma_f32 v37, v37, s20, v21
  v_mfma_f32_16x16x32_bf16 v[88:91], a[148:151], a[36:39], v[88:91]
  v_exp_f32 v48, v48
  v_mfma_f32_16x16x32_bf16 v[88:91], a[152:155], a[40:43], v[88:91]
  ds_read_b64_tr_b16 a[182:183], v9 offset:36864
  v_fma_f32 v38, v38, s20, v21
  v_mfma_f32_16x16x32_bf16 v[88:91], a[156:159], a[44:47], v[88:91]
  v_exp_f32 v49, v49
  v_mfma_f32_16x16x32_bf16 v[76:79], a[128:131], a[48:51], 0
  ds_read_b64_tr_b16 a[184:185], v10 offset:32768
  v_cvt_pk_bf16_f32 v98, v48, v49
  v_mfma_f32_16x16x32_bf16 v[76:79], a[132:135], a[52:55], v[76:79]
  v_exp_f32 v50, v50
  v_mfma_f32_16x16x32_bf16 v[76:79], a[136:139], a[56:59], v[76:79]
  ds_read_b64_tr_b16 a[186:187], v10 offset:36864
  v_fma_f32 v39, v39, s20, v21
  v_mfma_f32_16x16x32_bf16 v[76:79], a[140:143], a[60:63], v[76:79]
  v_exp_f32 v51, v51
  v_mfma_f32_16x16x32_bf16 v[92:95], a[144:147], a[48:51], 0
  ds_read_b64_tr_b16 a[188:189], v11 offset:32768
  v_cvt_pk_bf16_f32 v99, v50, v51
  v_mfma_f32_16x16x32_bf16 v[92:95], a[148:151], a[52:55], v[92:95]
  v_exp_f32 v36, v36
  v_mfma_f32_16x16x32_bf16 v[92:95], a[152:155], a[56:59], v[92:95]
  ds_read_b64_tr_b16 a[190:191], v11 offset:36864
  v_fma_f32 v52, v52, s20, v21
  v_mfma_f32_16x16x32_bf16 v[92:95], a[156:159], a[60:63], v[92:95]
  v_exp_f32 v37, v37
  v_mfma_f32_16x16x32_bf16 a[96:99], a[100:103], v[112:115], a[96:99]
  v_exp_f32 v38, v38
  v_mfma_f32_16x16x32_bf16 a[96:99], a[104:107], v[116:119], a[96:99]
  v_exp_f32 v39, v39
  v_mfma_f32_16x16x32_bf16 a[96:99], a[108:111], v[120:123], a[96:99]
  v_exp_f32 v52, v52
  v_mfma_f32_16x16x32_bf16 a[96:99], a[112:115], v[124:127], a[96:99]
  v_cvt_pk_bf16_f32 v100, v36, v37
  s_waitcnt lgkmcnt(1)
  v_mfma_f32_16x16x32_bf16 v[128:131], a[160:163], v[112:115], v[128:131]
  ds_read_b128 a[128:131], v0 offset:32768
  v_cvt_pk_bf16_f32 v101, v38, v39
  v_mfma_f32_16x16x32_bf16 v[160:163], a[160:163], v[116:119], v[160:163]
  v_fma_f32 v53, v53, s20, v21
  v_fma_f32 v54, v54, s20, v21
  v_mfma_f32_16x16x32_bf16 v[132:135], a[164:167], v[112:115], v[132:135]
  ds_read_b128 a[132:135], v1 offset:32768
  v_fma_f32 v55, v55, s20, v21
  v_mfma_f32_16x16x32_bf16 v[164:167], a[164:167], v[116:119], v[164:167]
  v_exp_f32 v53, v53
  v_mfma_f32_16x16x32_bf16 v[136:139], a[168:171], v[112:115], v[136:139]
  ds_read_b128 a[136:139], v2 offset:32768
  v_cvt_pk_bf16_f32 v102, v52, v53
  v_mfma_f32_16x16x32_bf16 v[168:171], a[168:171], v[116:119], v[168:171]
  v_exp_f32 v54, v54
  v_mfma_f32_16x16x32_bf16 v[140:143], a[172:175], v[112:115], v[140:143]
  ds_read_b128 a[140:143], v3 offset:32768
  v_fma_f32 v40, v40, s20, v22
  v_mfma_f32_16x16x32_bf16 v[172:175], a[172:175], v[116:119], v[172:175]
  v_exp_f32 v55, v55
  v_mfma_f32_16x16x32_bf16 v[144:147], a[176:179], v[112:115], v[144:147]
  ds_read_b128 a[144:147], v0 offset:36864
  v_cvt_pk_bf16_f32 v103, v54, v55
  v_mfma_f32_16x16x32_bf16 v[176:179], a[176:179], v[116:119], v[176:179]
  v_exp_f32 v40, v40
  v_mfma_f32_16x16x32_bf16 v[148:151], a[180:183], v[112:115], v[148:151]
  ds_read_b128 a[148:151], v1 offset:36864
  v_fma_f32 v41, v41, s20, v22
  v_mfma_f32_16x16x32_bf16 v[180:183], a[180:183], v[116:119], v[180:183]
  v_exp_f32 v41, v41
  v_mfma_f32_16x16x32_bf16 v[152:155], a[184:187], v[112:115], v[152:155]
  ds_read_b128 a[152:155], v2 offset:36864
  v_cvt_pk_bf16_f32 v104, v40, v41
  v_mfma_f32_16x16x32_bf16 v[184:187], a[184:187], v[116:119], v[184:187]
  v_fma_f32 v42, v42, s20, v22
  s_waitcnt lgkmcnt(3)
  v_mfma_f32_16x16x32_bf16 v[156:159], a[188:191], v[112:115], v[156:159]
  ds_read_b128 a[156:159], v3 offset:36864
  v_fma_f32 v43, v43, s20, v22
  v_mfma_f32_16x16x32_bf16 v[188:191], a[188:191], v[116:119], v[188:191]
  v_fma_f32 v56, v56, s20, v22
  s_add_u32 m0, s90, 0x0
  v_mfma_f32_16x16x32_bf16 v[192:195], a[160:163], v[120:123], v[192:195]
  buffer_load_dwordx4 v16, s[4:7], 0 offen offset:0 nt lds
  v_mfma_f32_16x16x32_bf16 v[224:227], a[160:163], v[124:127], v[224:227]
  v_exp_f32 v42, v42
  v_mfma_f32_16x16x32_bf16 v[196:199], a[164:167], v[120:123], v[196:199]
  v_exp_f32 v43, v43
  v_mfma_f32_16x16x32_bf16 v[228:231], a[164:167], v[124:127], v[228:231]
  v_exp_f32 v56, v56
  v_mfma_f32_16x16x32_bf16 v[200:203], a[168:171], v[120:123], v[200:203]
  v_cvt_pk_bf16_f32 v105, v42, v43
  v_fma_f32 v57, v57, s20, v22
  v_mfma_f32_16x16x32_bf16 v[232:235], a[168:171], v[124:127], v[232:235]
  v_exp_f32 v57, v57
  v_mfma_f32_16x16x32_bf16 v[204:207], a[172:175], v[120:123], v[204:207]
  v_fma_f32 v58, v58, s20, v22
  v_cvt_pk_bf16_f32 v106, v56, v57
  v_mfma_f32_16x16x32_bf16 v[236:239], a[172:175], v[124:127], v[236:239]
  v_exp_f32 v58, v58
  v_mfma_f32_16x16x32_bf16 v[208:211], a[176:179], v[120:123], v[208:211]
  v_fma_f32 v59, v59, s20, v22
  v_fma_f32 v44, v44, s20, v23
  v_mfma_f32_16x16x32_bf16 v[240:243], a[176:179], v[124:127], v[240:243]
  v_exp_f32 v59, v59
  v_mfma_f32_16x16x32_bf16 v[212:215], a[180:183], v[120:123], v[212:215]
  v_exp_f32 v44, v44
  v_mfma_f32_16x16x32_bf16 v[244:247], a[180:183], v[124:127], v[244:247]
  v_cvt_pk_bf16_f32 v107, v58, v59
  v_fma_f32 v45, v45, s20, v23
  v_mfma_f32_16x16x32_bf16 v[216:219], a[184:187], v[120:123], v[216:219]
  v_exp_f32 v45, v45
  v_mfma_f32_16x16x32_bf16 v[248:251], a[184:187], v[124:127], v[248:251]
  v_fma_f32 v46, v46, s20, v23
  v_cvt_pk_bf16_f32 v108, v44, v45
  v_mfma_f32_16x16x32_bf16 v[220:223], a[188:191], v[120:123], v[220:223]
  v_exp_f32 v46, v46
  v_mfma_f32_16x16x32_bf16 v[252:255], a[188:191], v[124:127], v[252:255]
  s_waitcnt vmcnt(13) lgkmcnt(0)
  s_barrier
  v_mfma_f32_16x16x32_bf16 v[32:35], a[128:131], a[0:3], 0
  ds_read_b64_tr_b16 a[160:161], v4 offset:0
  v_fma_f32 v47, v47, s20, v23
  v_mfma_f32_16x16x32_bf16 v[32:35], a[132:135], a[4:7], v[32:35]
  v_exp_f32 v47, v47
  v_mfma_f32_16x16x32_bf16 v[32:35], a[136:139], a[8:11], v[32:35]
  ds_read_b64_tr_b16 a[162:163], v4 offset:4096
  v_cvt_pk_bf16_f32 v109, v46, v47
  v_mfma_f32_16x16x32_bf16 v[32:35], a[140:143], a[12:15], v[32:35]
  s_add_u32 s16, s16, 0x2000
  s_and_b32 s16, s16, 0x1ffff
  v_mfma_f32_16x16x32_bf16 v[48:51], a[144:147], a[0:3], 0
  ds_read_b64_tr_b16 a[164:165], v5 offset:0
  v_fma_f32 v60, v60, s20, v23
  v_mfma_f32_16x16x32_bf16 v[48:51], a[148:151], a[4:7], v[48:51]
  v_fma_f32 v61, v61, s20, v23
  s_add_u32 m0, s19, 0xa000
  v_mfma_f32_16x16x32_bf16 v[48:51], a[152:155], a[8:11], v[48:51]
  ds_read_b64_tr_b16 a[166:167], v5 offset:4096
  v_fma_f32 v62, v62, s20, v23
  v_mfma_f32_16x16x32_bf16 v[48:51], a[156:159], a[12:15], v[48:51]
  buffer_load_dwordx4 v12, s[8:11], s16 offen offset:0 nt lds
  v_mfma_f32_16x16x32_bf16 v[36:39], a[128:131], a[16:19], 0
  ds_read_b64_tr_b16 a[168:169], v6 offset:0
  v_fma_f32 v63, v63, s20, v23
  v_mfma_f32_16x16x32_bf16 v[36:39], a[132:135], a[20:23], v[36:39]
  v_exp_f32 v60, v60
  v_mfma_f32_16x16x32_bf16 v[36:39], a[136:139], a[24:27], v[36:39]
  ds_read_b64_tr_b16 a[170:171], v6 offset:4096
  v_fma_f32 v64, v64, s20, v20
  v_mfma_f32_16x16x32_bf16 v[36:39], a[140:143], a[28:31], v[36:39]
  buffer_load_dwordx4 v13, s[8:11], s16 offen offset:1024 nt lds
  v_mfma_f32_16x16x32_bf16 v[52:55], a[144:147], a[16:19], 0
  ds_read_b64_tr_b16 a[172:173], v7 offset:0
  v_fma_f32 v65, v65, s20, v20
  v_mfma_f32_16x16x32_bf16 v[52:55], a[148:151], a[20:23], v[52:55]
  v_exp_f32 v61, v61
  v_mfma_f32_16x16x32_bf16 v[52:55], a[152:155], a[24:27], v[52:55]
  ds_read_b64_tr_b16 a[174:175], v7 offset:4096
  v_cvt_pk_bf16_f32 v110, v60, v61
  v_mfma_f32_16x16x32_bf16 v[52:55], a[156:159], a[28:31], v[52:55]
  buffer_load_dwordx4 v14, s[8:11], s16 offen offset:2048 nt lds
  v_mfma_f32_16x16x32_bf16 v[40:43], a[128:131], a[32:35], 0
  ds_read_b64_tr_b16 a[176:177], v8 offset:0
  v_fma_f32 v66, v66, s20, v20
  v_mfma_f32_16x16x32_bf16 v[40:43], a[132:135], a[36:39], v[40:43]
  v_exp_f32 v62, v62
  v_mfma_f32_16x16x32_bf16 v[40:43], a[136:139], a[40:43], v[40:43]
  ds_read_b64_tr_b16 a[178:179], v8 offset:4096
  v_fma_f32 v67, v67, s20, v20
  v_mfma_f32_16x16x32_bf16 v[40:43], a[140:143], a[44:47], v[40:43]
  buffer_load_dwordx4 v15, s[8:11], s16 offen offset:3072 nt lds
  v_mfma_f32_16x16x32_bf16 v[56:59], a[144:147], a[32:35], 0
  ds_read_b64_tr_b16 a[180:181], v9 offset:0
  v_fma_f32 v80, v80, s20, v20
  v_mfma_f32_16x16x32_bf16 v[56:59], a[148:151], a[36:39], v[56:59]
  v_exp_f32 v63, v63
  v_fma_f32 v81, v81, s20, v20
  v_mfma_f32_16x16x32_bf16 v[56:59], a[152:155], a[40:43], v[56:59]
  ds_read_b64_tr_b16 a[182:183], v9 offset:4096
  v_cvt_pk_bf16_f32 v111, v62, v63
  v_mfma_f32_16x16x32_bf16 v[56:59], a[156:159], a[44:47], v[56:59]
  v_exp_f32 v64, v64
  v_mfma_f32_16x16x32_bf16 v[44:47], a[128:131], a[48:51], 0
  ds_read_b64_tr_b16 a[184:185], v10 offset:0
  v_fma_f32 v82, v82, s20, v20
  v_mfma_f32_16x16x32_bf16 v[44:47], a[132:135], a[52:55], v[44:47]
  v_exp_f32 v65, v65
  v_mfma_f32_16x16x32_bf16 v[44:47], a[136:139], a[56:59], v[44:47]
  ds_read_b64_tr_b16 a[186:187], v10 offset:4096
  v_cvt_pk_bf16_f32 v112, v64, v65
  v_mfma_f32_16x16x32_bf16 v[44:47], a[140:143], a[60:63], v[44:47]
  v_exp_f32 v66, v66
  v_fma_f32 v83, v83, s20, v20
  v_mfma_f32_16x16x32_bf16 v[60:63], a[144:147], a[48:51], 0
  ds_read_b64_tr_b16 a[188:189], v11 offset:0
  v_fma_f32 v68, v68, s20, v21
  v_mfma_f32_16x16x32_bf16 v[60:63], a[148:151], a[52:55], v[60:63]
  v_exp_f32 v67, v67
  v_mfma_f32_16x16x32_bf16 v[60:63], a[152:155], a[56:59], v[60:63]
  ds_read_b64_tr_b16 a[190:191], v11 offset:4096
  v_cvt_pk_bf16_f32 v113, v66, v67
  v_mfma_f32_16x16x32_bf16 v[60:63], a[156:159], a[60:63], v[60:63]
  v_exp_f32 v80, v80
  v_mfma_f32_16x16x32_bf16 a[96:99], a[100:103], v[96:99], a[96:99]
  v_exp_f32 v81, v81
  v_mfma_f32_16x16x32_bf16 a[96:99], a[104:107], v[100:103], a[96:99]
  v_exp_f32 v82, v82
  v_mfma_f32_16x16x32_bf16 a[96:99], a[108:111], v[104:107], a[96:99]
  v_exp_f32 v83, v83
  v_cvt_pk_bf16_f32 v114, v80, v81
  v_mfma_f32_16x16x32_bf16 a[96:99], a[112:115], v[108:111], a[96:99]
  v_cvt_pk_bf16_f32 v115, v82, v83
  s_waitcnt lgkmcnt(1)
  v_mfma_f32_16x16x32_bf16 v[128:131], a[160:163], v[96:99], v[128:131]
  ds_read_b128 a[128:131], v0 offset:0
  v_fma_f32 v69, v69, s20, v21
  v_mfma_f32_16x16x32_bf16 v[160:163], a[160:163], v[100:103], v[160:163]
  v_exp_f32 v68, v68
  v_mfma_f32_16x16x32_bf16 v[132:135], a[164:167], v[96:99], v[132:135]
  ds_read_b128 a[132:135], v1 offset:0
  v_fma_f32 v70, v70, s20, v21
  v_mfma_f32_16x16x32_bf16 v[164:167], a[164:167], v[100:103], v[164:167]
  v_exp_f32 v69, v69
  v_mfma_f32_16x16x32_bf16 v[136:139], a[168:171], v[96:99], v[136:139]
  ds_read_b128 a[136:139], v2 offset:0
  v_exp_f32 v70, v70
  v_mfma_f32_16x16x32_bf16 v[168:171], a[168:171], v[100:103], v[168:171]
  v_cvt_pk_bf16_f32 v116, v68, v69
  v_fma_f32 v71, v71, s20, v21
  v_mfma_f32_16x16x32_bf16 v[140:143], a[172:175], v[96:99], v[140:143]
  ds_read_b128 a[140:143], v3 offset:0
  v_fma_f32 v84, v84, s20, v21
  v_mfma_f32_16x16x32_bf16 v[172:175], a[172:175], v[100:103], v[172:175]
  v_exp_f32 v71, v71
  v_mfma_f32_16x16x32_bf16 v[144:147], a[176:179], v[96:99], v[144:147]
  ds_read_b128 a[144:147], v0 offset:4096
  v_cvt_pk_bf16_f32 v117, v70, v71
  v_mfma_f32_16x16x32_bf16 v[176:179], a[176:179], v[100:103], v[176:179]
  v_exp_f32 v84, v84
  v_mfma_f32_16x16x32_bf16 v[148:151], a[180:183], v[96:99], v[148:151]
  ds_read_b128 a[148:151], v1 offset:4096
  v_fma_f32 v85, v85, s20, v21
  v_mfma_f32_16x16x32_bf16 v[180:183], a[180:183], v[100:103], v[180:183]
  v_exp_f32 v85, v85
  v_fma_f32 v86, v86, s20, v21
  v_mfma_f32_16x16x32_bf16 v[152:155], a[184:187], v[96:99], v[152:155]
  ds_read_b128 a[152:155], v2 offset:4096
  v_cvt_pk_bf16_f32 v118, v84, v85
  v_mfma_f32_16x16x32_bf16 v[184:187], a[184:187], v[100:103], v[184:187]
  v_fma_f32 v87, v87, s20, v21
  s_waitcnt lgkmcnt(3)
  v_mfma_f32_16x16x32_bf16 v[156:159], a[188:191], v[96:99], v[156:159]
  ds_read_b128 a[156:159], v3 offset:4096
  v_fma_f32 v72, v72, s20, v22
  v_mfma_f32_16x16x32_bf16 v[188:191], a[188:191], v[100:103], v[188:191]
  v_fma_f32 v73, v73, s20, v22
  s_add_u32 m0, s90, 0x0
  v_mfma_f32_16x16x32_bf16 v[192:195], a[160:163], v[104:107], v[192:195]
  buffer_load_dwordx4 v17, s[4:7], 0 offen offset:1024 nt lds
  v_mfma_f32_16x16x32_bf16 v[224:227], a[160:163], v[108:111], v[224:227]
  v_exp_f32 v86, v86
  v_fma_f32 v74, v74, s20, v22
  v_mfma_f32_16x16x32_bf16 v[196:199], a[164:167], v[104:107], v[196:199]
  v_exp_f32 v87, v87
  v_mfma_f32_16x16x32_bf16 v[228:231], a[164:167], v[108:111], v[228:231]
  v_exp_f32 v72, v72
  v_mfma_f32_16x16x32_bf16 v[200:203], a[168:171], v[104:107], v[200:203]
  buffer_load_dwordx4 v18, s[4:7], 0 offen offset:2048 nt lds
  v_mfma_f32_16x16x32_bf16 v[232:235], a[168:171], v[108:111], v[232:235]
  v_exp_f32 v73, v73
  v_mfma_f32_16x16x32_bf16 v[204:207], a[172:175], v[104:107], v[204:207]
  v_exp_f32 v74, v74
  v_mfma_f32_16x16x32_bf16 v[236:239], a[172:175], v[108:111], v[236:239]
  v_cvt_pk_bf16_f32 v119, v86, v87
  v_cvt_pk_bf16_f32 v120, v72, v73
  v_mfma_f32_16x16x32_bf16 v[208:211], a[176:179], v[104:107], v[208:211]
  v_fma_f32 v75, v75, s20, v22
  v_fma_f32 v88, v88, s20, v22
  v_fma_f32 v89, v89, s20, v22
  v_mfma_f32_16x16x32_bf16 v[240:243], a[176:179], v[108:111], v[240:243]
  v_exp_f32 v75, v75
  v_mfma_f32_16x16x32_bf16 v[212:215], a[180:183], v[104:107], v[212:215]
  v_exp_f32 v88, v88
  v_mfma_f32_16x16x32_bf16 v[244:247], a[180:183], v[108:111], v[244:247]
  v_exp_f32 v89, v89
  v_mfma_f32_16x16x32_bf16 v[216:219], a[184:187], v[104:107], v[216:219]
  v_cvt_pk_bf16_f32 v121, v74, v75
  v_cvt_pk_bf16_f32 v122, v88, v89
  v_mfma_f32_16x16x32_bf16 v[248:251], a[184:187], v[108:111], v[248:251]
  v_fma_f32 v90, v90, s20, v22
  v_fma_f32 v91, v91, s20, v22
  v_mfma_f32_16x16x32_bf16 v[220:223], a[188:191], v[104:107], v[220:223]
  v_exp_f32 v90, v90
  v_fma_f32 v76, v76, s20, v23
  v_mfma_f32_16x16x32_bf16 v[252:255], a[188:191], v[108:111], v[252:255]
  s_waitcnt vmcnt(15) lgkmcnt(0)
  s_barrier
  v_mfma_f32_16x16x32_bf16 v[64:67], a[128:131], a[0:3], 0
  ds_read_b64_tr_b16 a[160:161], v4 offset:8192
  v_fma_f32 v77, v77, s20, v23
  v_mfma_f32_16x16x32_bf16 v[64:67], a[132:135], a[4:7], v[64:67]
  v_exp_f32 v91, v91
  v_mfma_f32_16x16x32_bf16 v[64:67], a[136:139], a[8:11], v[64:67]
  ds_read_b64_tr_b16 a[162:163], v4 offset:12288
  v_cvt_pk_bf16_f32 v123, v90, v91
  v_mfma_f32_16x16x32_bf16 v[64:67], a[140:143], a[12:15], v[64:67]
  s_add_u32 s16, s16, 0x2000
  s_and_b32 s16, s16, 0x1ffff
  v_mfma_f32_16x16x32_bf16 v[80:83], a[144:147], a[0:3], 0
  ds_read_b64_tr_b16 a[164:165], v5 offset:8192
  v_fma_f32 v78, v78, s20, v23
  v_mfma_f32_16x16x32_bf16 v[80:83], a[148:151], a[4:7], v[80:83]
  v_fma_f32 v79, v79, s20, v23
  s_add_u32 m0, s19, 0x0
  v_mfma_f32_16x16x32_bf16 v[80:83], a[152:155], a[8:11], v[80:83]
  ds_read_b64_tr_b16 a[166:167], v5 offset:12288
  v_fma_f32 v92, v92, s20, v23
  v_mfma_f32_16x16x32_bf16 v[80:83], a[156:159], a[12:15], v[80:83]
  buffer_load_dwordx4 v12, s[8:11], s16 offen offset:0 nt lds
  v_mfma_f32_16x16x32_bf16 v[68:71], a[128:131], a[16:19], 0
  ds_read_b64_tr_b16 a[168:169], v6 offset:8192
  v_fma_f32 v93, v93, s20, v23
  v_mfma_f32_16x16x32_bf16 v[68:71], a[132:135], a[20:23], v[68:71]
  v_exp_f32 v76, v76
  v_mfma_f32_16x16x32_bf16 v[68:71], a[136:139], a[24:27], v[68:71]
  ds_read_b64_tr_b16 a[170:171], v6 offset:12288
  v_fma_f32 v94, v94, s20, v23
  v_mfma_f32_16x16x32_bf16 v[68:71], a[140:143], a[28:31], v[68:71]
  buffer_load_dwordx4 v13, s[8:11], s16 offen offset:1024 nt lds
  v_mfma_f32_16x16x32_bf16 v[84:87], a[144:147], a[16:19], 0
  ds_read_b64_tr_b16 a[172:173], v7 offset:8192
  v_exp_f32 v77, v77
  v_mfma_f32_16x16x32_bf16 v[84:87], a[148:151], a[20:23], v[84:87]
  v_exp_f32 v78, v78
  v_mfma_f32_16x16x32_bf16 v[84:87], a[152:155], a[24:27], v[84:87]
  ds_read_b64_tr_b16 a[174:175], v7 offset:12288
  v_cvt_pk_bf16_f32 v124, v76, v77
  v_mfma_f32_16x16x32_bf16 v[84:87], a[156:159], a[28:31], v[84:87]
  buffer_load_dwordx4 v14, s[8:11], s16 offen offset:2048 nt lds
  v_mfma_f32_16x16x32_bf16 v[72:75], a[128:131], a[32:35], 0
  ds_read_b64_tr_b16 a[176:177], v8 offset:8192
  v_exp_f32 v79, v79
  v_mfma_f32_16x16x32_bf16 v[72:75], a[132:135], a[36:39], v[72:75]
  v_exp_f32 v92, v92
  v_mfma_f32_16x16x32_bf16 v[72:75], a[136:139], a[40:43], v[72:75]
  ds_read_b64_tr_b16 a[178:179], v8 offset:12288
  v_cvt_pk_bf16_f32 v125, v78, v79
  v_mfma_f32_16x16x32_bf16 v[72:75], a[140:143], a[44:47], v[72:75]
  buffer_load_dwordx4 v15, s[8:11], s16 offen offset:3072 nt lds
  v_fma_f32 v95, v95, s20, v23
  v_mfma_f32_16x16x32_bf16 v[88:91], a[144:147], a[32:35], 0
  ds_read_b64_tr_b16 a[180:181], v9 offset:8192
  v_fma_f32 v32, v32, s20, v20
  v_mfma_f32_16x16x32_bf16 v[88:91], a[148:151], a[36:39], v[88:91]
  v_exp_f32 v93, v93
  v_mfma_f32_16x16x32_bf16 v[88:91], a[152:155], a[40:43], v[88:91]
  ds_read_b64_tr_b16 a[182:183], v9 offset:12288
  v_exp_f32 v94, v94
  v_mfma_f32_16x16x32_bf16 v[88:91], a[156:159], a[44:47], v[88:91]
  v_exp_f32 v95, v95
  v_mfma_f32_16x16x32_bf16 v[76:79], a[128:131], a[48:51], 0
  ds_read_b64_tr_b16 a[184:185], v10 offset:8192
  v_cvt_pk_bf16_f32 v126, v92, v93
  v_mfma_f32_16x16x32_bf16 v[76:79], a[132:135], a[52:55], v[76:79]
  v_cvt_pk_bf16_f32 v127, v94, v95
  v_exp_f32 v32, v32
  v_mfma_f32_16x16x32_bf16 v[76:79], a[136:139], a[56:59], v[76:79]
  ds_read_b64_tr_b16 a[186:187], v10 offset:12288
  v_fma_f32 v33, v33, s20, v20
  v_mfma_f32_16x16x32_bf16 v[76:79], a[140:143], a[60:63], v[76:79]
  v_exp_f32 v33, v33
  v_mfma_f32_16x16x32_bf16 v[92:95], a[144:147], a[48:51], 0
  ds_read_b64_tr_b16 a[188:189], v11 offset:8192
  v_cvt_pk_bf16_f32 v96, v32, v33
  v_fma_f32 v34, v34, s20, v20
  v_mfma_f32_16x16x32_bf16 v[92:95], a[148:151], a[52:55], v[92:95]
  v_exp_f32 v34, v34
  v_mfma_f32_16x16x32_bf16 v[92:95], a[152:155], a[56:59], v[92:95]
  ds_read_b64_tr_b16 a[190:191], v11 offset:12288
  v_fma_f32 v35, v35, s20, v20
  v_mfma_f32_16x16x32_bf16 v[92:95], a[156:159], a[60:63], v[92:95]
  v_exp_f32 v35, v35
  v_fma_f32 v48, v48, s20, v20
  v_mfma_f32_16x16x32_bf16 a[96:99], a[100:103], v[112:115], a[96:99]
  v_exp_f32 v48, v48
  v_mfma_f32_16x16x32_bf16 a[96:99], a[104:107], v[116:119], a[96:99]
  v_cvt_pk_bf16_f32 v97, v34, v35
  v_fma_f32 v49, v49, s20, v20
  v_mfma_f32_16x16x32_bf16 a[96:99], a[108:111], v[120:123], a[96:99]
  v_exp_f32 v49, v49
  v_fma_f32 v50, v50, s20, v20
  v_mfma_f32_16x16x32_bf16 a[96:99], a[112:115], v[124:127], a[96:99]
  v_cvt_pk_bf16_f32 v98, v48, v49
  s_waitcnt lgkmcnt(1)
  v_mfma_f32_16x16x32_bf16 v[128:131], a[160:163], v[112:115], v[128:131]
  ds_read_b128 a[128:131], v0 offset:8192
  v_fma_f32 v51, v51, s20, v20
  v_mfma_f32_16x16x32_bf16 v[160:163], a[160:163], v[116:119], v[160:163]
  v_exp_f32 v50, v50
  v_fma_f32 v36, v36, s20, v21
  v_mfma_f32_16x16x32_bf16 v[132:135], a[164:167], v[112:115], v[132:135]
  ds_read_b128 a[132:135], v1 offset:8192
  v_fma_f32 v37, v37, s20, v21
  v_mfma_f32_16x16x32_bf16 v[164:167], a[164:167], v[116:119], v[164:167]
  v_exp_f32 v51, v51
  v_mfma_f32_16x16x32_bf16 v[136:139], a[168:171], v[112:115], v[136:139]
  ds_read_b128 a[136:139], v2 offset:8192
  v_cvt_pk_bf16_f32 v99, v50, v51
  v_fma_f32 v38, v38, s20, v21
  v_mfma_f32_16x16x32_bf16 v[168:171], a[168:171], v[116:119], v[168:171]
  v_exp_f32 v36, v36
  v_mfma_f32_16x16x32_bf16 v[140:143], a[172:175], v[112:115], v[140:143]
  ds_read_b128 a[140:143], v3 offset:8192
  v_fma_f32 v39, v39, s20, v21
  v_mfma_f32_16x16x32_bf16 v[172:175], a[172:175], v[116:119], v[172:175]
  v_exp_f32 v37, v37
  v_fma_f32 v52, v52, s20, v21
  v_mfma_f32_16x16x32_bf16 v[144:147], a[176:179], v[112:115], v[144:147]
  ds_read_b128 a[144:147], v0 offset:12288
  v_cvt_pk_bf16_f32 v100, v36, v37
  v_mfma_f32_16x16x32_bf16 v[176:179], a[176:179], v[116:119], v[176:179]
  v_exp_f32 v38, v38
  v_mfma_f32_16x16x32_bf16 v[148:151], a[180:183], v[112:115], v[148:151]
  ds_read_b128 a[148:151], v1 offset:12288
  v_exp_f32 v39, v39
  v_mfma_f32_16x16x32_bf16 v[180:183], a[180:183], v[116:119], v[180:183]
  v_exp_f32 v52, v52
  v_mfma_f32_16x16x32_bf16 v[152:155], a[184:187], v[112:115], v[152:155]
  ds_read_b128 a[152:155], v2 offset:12288
  v_cvt_pk_bf16_f32 v101, v38, v39
  v_mfma_f32_16x16x32_bf16 v[184:187], a[184:187], v[116:119], v[184:187]
  v_fma_f32 v53, v53, s20, v21
  v_fma_f32 v54, v54, s20, v21
  s_waitcnt lgkmcnt(3)
  v_mfma_f32_16x16x32_bf16 v[156:159], a[188:191], v[112:115], v[156:159]
  ds_read_b128 a[156:159], v3 offset:12288
  v_fma_f32 v55, v55, s20, v21
  v_mfma_f32_16x16x32_bf16 v[188:191], a[188:191], v[116:119], v[188:191]
  v_fma_f32 v40, v40, s20, v22
  s_add_u32 m0, s90, 0x0
  v_mfma_f32_16x16x32_bf16 v[192:195], a[160:163], v[120:123], v[192:195]
  buffer_load_dwordx4 v19, s[4:7], 0 offen offset:3072 nt lds
  v_fma_f32 v41, v41, s20, v22
  v_mfma_f32_16x16x32_bf16 v[224:227], a[160:163], v[124:127], v[224:227]
  v_exp_f32 v53, v53
  v_mfma_f32_16x16x32_bf16 v[196:199], a[164:167], v[120:123], v[196:199]
  v_exp_f32 v54, v54
  v_mfma_f32_16x16x32_bf16 v[228:231], a[164:167], v[124:127], v[228:231]
  v_exp_f32 v55, v55
  v_cvt_pk_bf16_f32 v102, v52, v53
  v_mfma_f32_16x16x32_bf16 v[200:203], a[168:171], v[120:123], v[200:203]
  v_exp_f32 v40, v40
  v_mfma_f32_16x16x32_bf16 v[232:235], a[168:171], v[124:127], v[232:235]
  v_exp_f32 v41, v41
  v_mfma_f32_16x16x32_bf16 v[204:207], a[172:175], v[120:123], v[204:207]
  v_cvt_pk_bf16_f32 v103, v54, v55
  v_cvt_pk_bf16_f32 v104, v40, v41
  v_fma_f32 v42, v42, s20, v22
  v_mfma_f32_16x16x32_bf16 v[236:239], a[172:175], v[124:127], v[236:239]
  v_exp_f32 v42, v42
  v_mfma_f32_16x16x32_bf16 v[208:211], a[176:179], v[120:123], v[208:211]
  v_fma_f32 v43, v43, s20, v22
  v_fma_f32 v56, v56, s20, v22
  v_mfma_f32_16x16x32_bf16 v[240:243], a[176:179], v[124:127], v[240:243]
  v_exp_f32 v43, v43
  v_fma_f32 v57, v57, s20, v22
  v_mfma_f32_16x16x32_bf16 v[212:215], a[180:183], v[120:123], v[212:215]
  buffer_store_dwordx4 a[192:195], v16, s[12:15], 0 offen offset:0 nt
  v_mfma_f32_16x16x32_bf16 v[244:247], a[180:183], v[124:127], v[244:247]
  v_exp_f32 v56, v56
  v_mfma_f32_16x16x32_bf16 v[216:219], a[184:187], v[120:123], v[216:219]
  v_exp_f32 v57, v57
  v_mfma_f32_16x16x32_bf16 v[248:251], a[184:187], v[124:127], v[248:251]
  v_cvt_pk_bf16_f32 v105, v42, v43
  v_cvt_pk_bf16_f32 v106, v56, v57
  v_fma_f32 v58, v58, s20, v22
  v_mfma_f32_16x16x32_bf16 v[220:223], a[188:191], v[120:123], v[220:223]
  v_exp_f32 v58, v58
  v_mfma_f32_16x16x32_bf16 v[252:255], a[188:191], v[124:127], v[252:255]
  s_waitcnt vmcnt(17) lgkmcnt(0)
  s_barrier
  v_mfma_f32_16x16x32_bf16 v[32:35], a[128:131], a[0:3], 0
  ds_read_b64_tr_b16 a[160:161], v4 offset:16384
  v_fma_f32 v59, v59, s20, v22
  v_mfma_f32_16x16x32_bf16 v[32:35], a[132:135], a[4:7], v[32:35]
  v_exp_f32 v59, v59
  v_mfma_f32_16x16x32_bf16 v[32:35], a[136:139], a[8:11], v[32:35]
  ds_read_b64_tr_b16 a[162:163], v4 offset:20480
  v_cvt_pk_bf16_f32 v107, v58, v59
  v_mfma_f32_16x16x32_bf16 v[32:35], a[140:143], a[12:15], v[32:35]
  s_add_u32 s16, s16, 0x2000
  s_and_b32 s16, s16, 0x1ffff
  v_mfma_f32_16x16x32_bf16 v[48:51], a[144:147], a[0:3], 0
  ds_read_b64_tr_b16 a[164:165], v5 offset:16384
  v_fma_f32 v44, v44, s20, v23
  v_mfma_f32_16x16x32_bf16 v[48:51], a[148:151], a[4:7], v[48:51]
  v_fma_f32 v45, v45, s20, v23
  s_add_u32 m0, s19, 0x2000
  v_mfma_f32_16x16x32_bf16 v[48:51], a[152:155], a[8:11], v[48:51]
  ds_read_b64_tr_b16 a[166:167], v5 offset:20480
  v_fma_f32 v46, v46, s20, v23
  v_mfma_f32_16x16x32_bf16 v[48:51], a[156:159], a[12:15], v[48:51]
  buffer_load_dwordx4 v12, s[8:11], s16 offen offset:0 nt lds
  v_mfma_f32_16x16x32_bf16 v[36:39], a[128:131], a[16:19], 0
  ds_read_b64_tr_b16 a[168:169], v6 offset:16384
  v_exp_f32 v44, v44
  v_mfma_f32_16x16x32_bf16 v[36:39], a[132:135], a[20:23], v[36:39]
  v_exp_f32 v45, v45
  v_mfma_f32_16x16x32_bf16 v[36:39], a[136:139], a[24:27], v[36:39]
  ds_read_b64_tr_b16 a[170:171], v6 offset:20480
  v_cvt_pk_bf16_f32 v108, v44, v45
  v_mfma_f32_16x16x32_bf16 v[36:39], a[140:143], a[28:31], v[36:39]
  buffer_load_dwordx4 v13, s[8:11], s16 offen offset:1024 nt lds
  v_mfma_f32_16x16x32_bf16 v[52:55], a[144:147], a[16:19], 0
  ds_read_b64_tr_b16 a[172:173], v7 offset:16384
  v_fma_f32 v47, v47, s20, v23
  v_mfma_f32_16x16x32_bf16 v[52:55], a[148:151], a[20:23], v[52:55]
  v_exp_f32 v46, v46
  v_mfma_f32_16x16x32_bf16 v[52:55], a[152:155], a[24:27], v[52:55]
  ds_read_b64_tr_b16 a[174:175], v7 offset:20480
  v_exp_f32 v47, v47
  v_mfma_f32_16x16x32_bf16 v[52:55], a[156:159], a[28:31], v[52:55]
  buffer_load_dwordx4 v14, s[8:11], s16 offen offset:2048 nt lds
  v_mfma_f32_16x16x32_bf16 v[40:43], a[128:131], a[32:35], 0
  ds_read_b64_tr_b16 a[176:177], v8 offset:16384
  v_cvt_pk_bf16_f32 v109, v46, v47
  v_mfma_f32_16x16x32_bf16 v[40:43], a[132:135], a[36:39], v[40:43]
  v_fma_f32 v60, v60, s20, v23
  v_fma_f32 v61, v61, s20, v23
  v_mfma_f32_16x16x32_bf16 v[40:43], a[136:139], a[40:43], v[40:43]
  ds_read_b64_tr_b16 a[178:179], v8 offset:20480
  v_exp_f32 v60, v60
  v_mfma_f32_16x16x32_bf16 v[40:43], a[140:143], a[44:47], v[40:43]
  buffer_load_dwordx4 v15, s[8:11], s16 offen offset:3072 nt lds
  v_mfma_f32_16x16x32_bf16 v[56:59], a[144:147], a[32:35], 0
  ds_read_b64_tr_b16 a[180:181], v9 offset:16384
  v_fma_f32 v62, v62, s20, v23
  v_mfma_f32_16x16x32_bf16 v[56:59], a[148:151], a[36:39], v[56:59]
  v_exp_f32 v61, v61
  v_fma_f32 v63, v63, s20, v23
  v_mfma_f32_16x16x32_bf16 v[56:59], a[152:155], a[40:43], v[56:59]
  ds_read_b64_tr_b16 a[182:183], v9 offset:20480
  v_cvt_pk_bf16_f32 v110, v60, v61
  v_mfma_f32_16x16x32_bf16 v[56:59], a[156:159], a[44:47], v[56:59]
  v_exp_f32 v62, v62
  v_mfma_f32_16x16x32_bf16 v[44:47], a[128:131], a[48:51], 0
  ds_read_b64_tr_b16 a[184:185], v10 offset:16384
  v_exp_f32 v63, v63
  v_mfma_f32_16x16x32_bf16 v[44:47], a[132:135], a[52:55], v[44:47]
  v_fma_f32 v64, v64, s20, v20
  v_cvt_pk_bf16_f32 v111, v62, v63
  v_mfma_f32_16x16x32_bf16 v[44:47], a[136:139], a[56:59], v[44:47]
  ds_read_b64_tr_b16 a[186:187], v10 offset:20480
  v_fma_f32 v65, v65, s20, v20
  v_mfma_f32_16x16x32_bf16 v[44:47], a[140:143], a[60:63], v[44:47]
  v_exp_f32 v64, v64
  v_mfma_f32_16x16x32_bf16 v[60:63], a[144:147], a[48:51], 0
  ds_read_b64_tr_b16 a[188:189], v11 offset:16384
  v_exp_f32 v65, v65
  v_mfma_f32_16x16x32_bf16 v[60:63], a[148:151], a[52:55], v[60:63]
  v_fma_f32 v66, v66, s20, v20
  v_cvt_pk_bf16_f32 v112, v64, v65
  v_mfma_f32_16x16x32_bf16 v[60:63], a[152:155], a[56:59], v[60:63]
  ds_read_b64_tr_b16 a[190:191], v11 offset:20480
  v_fma_f32 v67, v67, s20, v20
  v_mfma_f32_16x16x32_bf16 v[60:63], a[156:159], a[60:63], v[60:63]
  v_exp_f32 v66, v66
  v_fma_f32 v80, v80, s20, v20
  v_mfma_f32_16x16x32_bf16 a[96:99], a[100:103], v[96:99], a[96:99]
  v_exp_f32 v67, v67
  v_mfma_f32_16x16x32_bf16 a[96:99], a[104:107], v[100:103], a[96:99]
  v_exp_f32 v80, v80
  v_mfma_f32_16x16x32_bf16 a[96:99], a[108:111], v[104:107], a[96:99]
  v_cvt_pk_bf16_f32 v113, v66, v67
  v_fma_f32 v81, v81, s20, v20
  v_fma_f32 v82, v82, s20, v20
  v_mfma_f32_16x16x32_bf16 a[96:99], a[112:115], v[108:111], a[96:99]
  v_fma_f32 v83, v83, s20, v20
  s_waitcnt lgkmcnt(1)
  v_mfma_f32_16x16x32_bf16 v[128:131], a[160:163], v[96:99], v[128:131]
  ds_read_b128 a[128:131], v0 offset:16384
  v_fma_f32 v68, v68, s20, v21
  v_mfma_f32_16x16x32_bf16 v[160:163], a[160:163], v[100:103], v[160:163]
  v_exp_f32 v81, v81
  v_mfma_f32_16x16x32_bf16 v[132:135], a[164:167], v[96:99], v[132:135]
  ds_read_b128 a[132:135], v1 offset:16384
  v_exp_f32 v82, v82
  v_mfma_f32_16x16x32_bf16 v[164:167], a[164:167], v[100:103], v[164:167]
  v_exp_f32 v83, v83
  v_mfma_f32_16x16x32_bf16 v[136:139], a[168:171], v[96:99], v[136:139]
  ds_read_b128 a[136:139], v2 offset:16384
  v_cvt_pk_bf16_f32 v114, v80, v81
  v_mfma_f32_16x16x32_bf16 v[168:171], a[168:171], v[100:103], v[168:171]
  v_cvt_pk_bf16_f32 v115, v82, v83
  v_exp_f32 v68, v68
  v_mfma_f32_16x16x32_bf16 v[140:143], a[172:175], v[96:99], v[140:143]
  ds_read_b128 a[140:143], v3 offset:16384
  v_fma_f32 v69, v69, s20, v21
  v_mfma_f32_16x16x32_bf16 v[172:175], a[172:175], v[100:103], v[172:175]
  v_exp_f32 v69, v69
  v_mfma_f32_16x16x32_bf16 v[144:147], a[176:179], v[96:99], v[144:147]
  ds_read_b128 a[144:147], v0 offset:20480
  v_cvt_pk_bf16_f32 v116, v68, v69
  v_fma_f32 v70, v70, s20, v21
  v_mfma_f32_16x16x32_bf16 v[176:179], a[176:179], v[100:103], v[176:179]
  v_exp_f32 v70, v70
  v_mfma_f32_16x16x32_bf16 v[148:151], a[180:183], v[96:99], v[148:151]
  ds_read_b128 a[148:151], v1 offset:20480
  v_fma_f32 v71, v71, s20, v21
  v_mfma_f32_16x16x32_bf16 v[180:183], a[180:183], v[100:103], v[180:183]
  v_exp_f32 v71, v71
  v_mfma_f32_16x16x32_bf16 v[152:155], a[184:187], v[96:99], v[152:155]
  ds_read_b128 a[152:155], v2 offset:20480
  v_cvt_pk_bf16_f32 v117, v70, v71
  v_fma_f32 v84, v84, s20, v21
  v_mfma_f32_16x16x32_bf16 v[184:187], a[184:187], v[100:103], v[184:187]
  v_fma_f32 v85, v85, s20, v21
  s_waitcnt lgkmcnt(3)
  v_mfma_f32_16x16x32_bf16 v[156:159], a[188:191], v[96:99], v[156:159]
  ds_read_b128 a[156:159], v3 offset:20480
  v_fma_f32 v86, v86, s20, v21
  v_mfma_f32_16x16x32_bf16 v[188:191], a[188:191], v[100:103], v[188:191]
  v_exp_f32 v84, v84
  s_add_u32 m0, s90, 0x1000
  v_mfma_f32_16x16x32_bf16 v[192:195], a[160:163], v[104:107], v[192:195]
  buffer_load_dwordx4 v16, s[4:7], s87 offen offset:0 nt lds
  v_mfma_f32_16x16x32_bf16 v[224:227], a[160:163], v[108:111], v[224:227]
  v_exp_f32 v85, v85
  v_mfma_f32_16x16x32_bf16 v[196:199], a[164:167], v[104:107], v[196:199]
  v_exp_f32 v86, v86
  v_cvt_pk_bf16_f32 v118, v84, v85
  v_mfma_f32_16x16x32_bf16 v[228:231], a[164:167], v[108:111], v[228:231]
  v_fma_f32 v87, v87, s20, v21
  v_fma_f32 v72, v72, s20, v22
  v_mfma_f32_16x16x32_bf16 v[200:203], a[168:171], v[104:107], v[200:203]
  buffer_load_dwordx4 v17, s[4:7], s87 offen offset:1024 nt lds
  v_mfma_f32_16x16x32_bf16 v[232:235], a[168:171], v[108:111], v[232:235]
  v_exp_f32 v87, v87
  v_mfma_f32_16x16x32_bf16 v[204:207], a[172:175], v[104:107], v[204:207]
  v_exp_f32 v72, v72
  v_cvt_pk_bf16_f32 v119, v86, v87
  v_mfma_f32_16x16x32_bf16 v[236:239], a[172:175], v[108:111], v[236:239]
  v_fma_f32 v73, v73, s20, v22
  v_fma_f32 v74, v74, s20, v22
  v_mfma_f32_16x16x32_bf16 v[208:211], a[176:179], v[104:107], v[208:211]
  v_exp_f32 v73, v73
  v_mfma_f32_16x16x32_bf16 v[240:243], a[176:179], v[108:111], v[240:243]
  v_exp_f32 v74, v74
  v_cvt_pk_bf16_f32 v120, v72, v73
  v_mfma_f32_16x16x32_bf16 v[212:215], a[180:183], v[104:107], v[212:215]
  v_fma_f32 v75, v75, s20, v22
  v_fma_f32 v88, v88, s20, v22
  v_mfma_f32_16x16x32_bf16 v[244:247], a[180:183], v[108:111], v[244:247]
  v_exp_f32 v75, v75
  v_mfma_f32_16x16x32_bf16 v[216:219], a[184:187], v[104:107], v[216:219]
  v_exp_f32 v88, v88
  v_cvt_pk_bf16_f32 v121, v74, v75
  v_mfma_f32_16x16x32_bf16 v[248:251], a[184:187], v[108:111], v[248:251]
  v_fma_f32 v89, v89, s20, v22
  v_fma_f32 v90, v90, s20, v22
  v_mfma_f32_16x16x32_bf16 v[220:223], a[188:191], v[104:107], v[220:223]
  v_exp_f32 v89, v89
  v_mfma_f32_16x16x32_bf16 v[252:255], a[188:191], v[108:111], v[252:255]
  s_waitcnt vmcnt(19) lgkmcnt(0)
  s_barrier
  v_mfma_f32_16x16x32_bf16 v[64:67], a[128:131], a[0:3], 0
  ds_read_b64_tr_b16 a[160:161], v4 offset:24576
  v_cvt_pk_bf16_f32 v122, v88, v89
  v_mfma_f32_16x16x32_bf16 v[64:67], a[132:135], a[4:7], v[64:67]
  v_exp_f32 v90, v90
  v_mfma_f32_16x16x32_bf16 v[64:67], a[136:139], a[8:11], v[64:67]
  ds_read_b64_tr_b16 a[162:163], v4 offset:28672
  v_fma_f32 v91, v91, s20, v22
  v_mfma_f32_16x16x32_bf16 v[64:67], a[140:143], a[12:15], v[64:67]
  s_add_u32 s16, s16, 0x2000
  s_and_b32 s16, s16, 0x1ffff
  v_mfma_f32_16x16x32_bf16 v[80:83], a[144:147], a[0:3], 0
  ds_read_b64_tr_b16 a[164:165], v5 offset:24576
  v_fma_f32 v76, v76, s20, v23
  v_mfma_f32_16x16x32_bf16 v[80:83], a[148:151], a[4:7], v[80:83]
  v_fma_f32 v77, v77, s20, v23
  s_add_u32 m0, s19, 0x4000
  v_mfma_f32_16x16x32_bf16 v[80:83], a[152:155], a[8:11], v[80:83]
  ds_read_b64_tr_b16 a[166:167], v5 offset:28672
  v_exp_f32 v91, v91
  v_mfma_f32_16x16x32_bf16 v[80:83], a[156:159], a[12:15], v[80:83]
  buffer_load_dwordx4 v12, s[8:11], s16 offen offset:0 nt lds
  v_mfma_f32_16x16x32_bf16 v[68:71], a[128:131], a[16:19], 0
  ds_read_b64_tr_b16 a[168:169], v6 offset:24576
  v_cvt_pk_bf16_f32 v123, v90, v91
  v_mfma_f32_16x16x32_bf16 v[68:71], a[132:135], a[20:23], v[68:71]
  v_exp_f32 v76, v76
  v_mfma_f32_16x16x32_bf16 v[68:71], a[136:139], a[24:27], v[68:71]
  ds_read_b64_tr_b16 a[170:171], v6 offset:28672
  v_fma_f32 v78, v78, s20, v23
  v_mfma_f32_16x16x32_bf16 v[68:71], a[140:143], a[28:31], v[68:71]
  buffer_load_dwordx4 v13, s[8:11], s16 offen offset:1024 nt lds
  v_mfma_f32_16x16x32_bf16 v[84:87], a[144:147], a[16:19], 0
  ds_read_b64_tr_b16 a[172:173], v7 offset:24576
  v_exp_f32 v77, v77
  v_mfma_f32_16x16x32_bf16 v[84:87], a[148:151], a[20:23], v[84:87]
  v_exp_f32 v78, v78
  v_mfma_f32_16x16x32_bf16 v[84:87], a[152:155], a[24:27], v[84:87]
  ds_read_b64_tr_b16 a[174:175], v7 offset:28672
  v_cvt_pk_bf16_f32 v124, v76, v77
  v_mfma_f32_16x16x32_bf16 v[84:87], a[156:159], a[28:31], v[84:87]
  buffer_load_dwordx4 v14, s[8:11], s16 offen offset:2048 nt lds
  v_mfma_f32_16x16x32_bf16 v[72:75], a[128:131], a[32:35], 0
  ds_read_b64_tr_b16 a[176:177], v8 offset:24576
  v_fma_f32 v79, v79, s20, v23
  v_fma_f32 v92, v92, s20, v23
  v_mfma_f32_16x16x32_bf16 v[72:75], a[132:135], a[36:39], v[72:75]
  v_exp_f32 v79, v79
  v_mfma_f32_16x16x32_bf16 v[72:75], a[136:139], a[40:43], v[72:75]
  ds_read_b64_tr_b16 a[178:179], v8 offset:28672
  v_cvt_pk_bf16_f32 v125, v78, v79
  v_mfma_f32_16x16x32_bf16 v[72:75], a[140:143], a[44:47], v[72:75]
  buffer_load_dwordx4 v15, s[8:11], s16 offen offset:3072 nt lds
  v_fma_f32 v93, v93, s20, v23
  v_mfma_f32_16x16x32_bf16 v[88:91], a[144:147], a[32:35], 0
  ds_read_b64_tr_b16 a[180:181], v9 offset:24576
  v_fma_f32 v94, v94, s20, v23
  v_mfma_f32_16x16x32_bf16 v[88:91], a[148:151], a[36:39], v[88:91]
  v_exp_f32 v92, v92
  v_mfma_f32_16x16x32_bf16 v[88:91], a[152:155], a[40:43], v[88:91]
  ds_read_b64_tr_b16 a[182:183], v9 offset:28672
  v_exp_f32 v93, v93
  v_mfma_f32_16x16x32_bf16 v[88:91], a[156:159], a[44:47], v[88:91]
  v_exp_f32 v94, v94
  v_mfma_f32_16x16x32_bf16 v[76:79], a[128:131], a[48:51], 0
  ds_read_b64_tr_b16 a[184:185], v10 offset:24576
  v_cvt_pk_bf16_f32 v126, v92, v93
  v_mfma_f32_16x16x32_bf16 v[76:79], a[132:135], a[52:55], v[76:79]
  v_fma_f32 v95, v95, s20, v23
  v_fma_f32 v32, v32, s20, v20
  v_fma_f32 v33, v33, s20, v20
  v_mfma_f32_16x16x32_bf16 v[76:79], a[136:139], a[56:59], v[76:79]
  ds_read_b64_tr_b16 a[186:187], v10 offset:28672
  v_fma_f32 v34, v34, s20, v20
  v_mfma_f32_16x16x32_bf16 v[76:79], a[140:143], a[60:63], v[76:79]
  v_exp_f32 v95, v95
  v_fma_f32 v35, v35, s20, v20
  v_fma_f32 v48, v48, s20, v20
  v_cvt_pk_bf16_f32 v127, v94, v95
  v_mfma_f32_16x16x32_bf16 v[92:95], a[144:147], a[48:51], 0
  ds_read_b64_tr_b16 a[188:189], v11 offset:24576
  v_fma_f32 v49, v49, s20, v20
  v_mfma_f32_16x16x32_bf16 v[92:95], a[148:151], a[52:55], v[92:95]
  v_exp_f32 v32, v32
  v_fma_f32 v50, v50, s20, v20
  v_mfma_f32_16x16x32_bf16 v[92:95], a[152:155], a[56:59], v[92:95]
  ds_read_b64_tr_b16 a[190:191], v11 offset:28672
  v_fma_f32 v51, v51, s20, v20
  v_mfma_f32_16x16x32_bf16 v[92:95], a[156:159], a[60:63], v[92:95]
  v_exp_f32 v33, v33
  v_mfma_f32_16x16x32_bf16 a[96:99], a[100:103], v[112:115], a[96:99]
  v_exp_f32 v34, v34
  v_cvt_pk_bf16_f32 v96, v32, v33
  v_mfma_f32_16x16x32_bf16 a[96:99], a[104:107], v[116:119], a[96:99]
  v_exp_f32 v35, v35
  v_mfma_f32_16x16x32_bf16 a[96:99], a[108:111], v[120:123], a[96:99]
  v_exp_f32 v48, v48
  v_mfma_f32_16x16x32_bf16 a[96:99], a[112:115], v[124:127], a[96:99]
  v_cvt_pk_bf16_f32 v97, v34, v35
  s_waitcnt lgkmcnt(1)
  v_mfma_f32_16x16x32_bf16 v[128:131], a[160:163], v[112:115], v[128:131]
  ds_read_b128 a[128:131], v0 offset:24576
  v_exp_f32 v49, v49
  v_mfma_f32_16x16x32_bf16 v[160:163], a[160:163], v[116:119], v[160:163]
  v_exp_f32 v50, v50
  v_mfma_f32_16x16x32_bf16 v[132:135], a[164:167], v[112:115], v[132:135]
  ds_read_b128 a[132:135], v1 offset:24576
  v_cvt_pk_bf16_f32 v98, v48, v49
  v_mfma_f32_16x16x32_bf16 v[164:167], a[164:167], v[116:119], v[164:167]
  v_exp_f32 v51, v51
  v_fma_f32 v36, v36, s20, v21
  v_mfma_f32_16x16x32_bf16 v[136:139], a[168:171], v[112:115], v[136:139]
  ds_read_b128 a[136:139], v2 offset:24576
  v_cvt_pk_bf16_f32 v99, v50, v51
  v_mfma_f32_16x16x32_bf16 v[168:171], a[168:171], v[116:119], v[168:171]
  v_exp_f32 v36, v36
  v_mfma_f32_16x16x32_bf16 v[140:143], a[172:175], v[112:115], v[140:143]
  ds_read_b128 a[140:143], v3 offset:24576
  v_fma_f32 v37, v37, s20, v21
  v_mfma_f32_16x16x32_bf16 v[172:175], a[172:175], v[116:119], v[172:175]
  v_exp_f32 v37, v37
  v_fma_f32 v38, v38, s20, v21
  v_mfma_f32_16x16x32_bf16 v[144:147], a[176:179], v[112:115], v[144:147]
  ds_read_b128 a[144:147], v0 offset:28672
  v_cvt_pk_bf16_f32 v100, v36, v37
  v_mfma_f32_16x16x32_bf16 v[176:179], a[176:179], v[116:119], v[176:179]
  v_exp_f32 v38, v38
  v_mfma_f32_16x16x32_bf16 v[148:151], a[180:183], v[112:115], v[148:151]
  ds_read_b128 a[148:151], v1 offset:28672
  v_fma_f32 v39, v39, s20, v21
  v_fma_f32 v52, v52, s20, v21
  v_mfma_f32_16x16x32_bf16 v[180:183], a[180:183], v[116:119], v[180:183]
  v_exp_f32 v39, v39
  v_mfma_f32_16x16x32_bf16 v[152:155], a[184:187], v[112:115], v[152:155]
  ds_read_b128 a[152:155], v2 offset:28672
  v_cvt_pk_bf16_f32 v101, v38, v39
  v_mfma_f32_16x16x32_bf16 v[184:187], a[184:187], v[116:119], v[184:187]
  v_exp_f32 v52, v52
  s_waitcnt lgkmcnt(3)
  v_mfma_f32_16x16x32_bf16 v[156:159], a[188:191], v[112:115], v[156:159]
  ds_read_b128 a[156:159], v3 offset:28672
  v_fma_f32 v53, v53, s20, v21
  v_mfma_f32_16x16x32_bf16 v[188:191], a[188:191], v[116:119], v[188:191]
  v_fma_f32 v54, v54, s20, v21
  s_add_u32 m0, s90, 0x1000
  v_mfma_f32_16x16x32_bf16 v[192:195], a[160:163], v[120:123], v[192:195]
  buffer_load_dwordx4 v18, s[4:7], s87 offen offset:2048 nt lds
  v_mfma_f32_16x16x32_bf16 v[224:227], a[160:163], v[124:127], v[224:227]
  v_exp_f32 v53, v53
  v_fma_f32 v55, v55, s20, v21
  v_mfma_f32_16x16x32_bf16 v[196:199], a[164:167], v[120:123], v[196:199]
  v_exp_f32 v54, v54
  v_mfma_f32_16x16x32_bf16 v[228:231], a[164:167], v[124:127], v[228:231]
  v_exp_f32 v55, v55
  v_mfma_f32_16x16x32_bf16 v[200:203], a[168:171], v[120:123], v[200:203]
  buffer_load_dwordx4 v19, s[4:7], s87 offen offset:3072 nt lds
  v_cvt_pk_bf16_f32 v102, v52, v53
  v_mfma_f32_16x16x32_bf16 v[232:235], a[168:171], v[124:127], v[232:235]
  v_cvt_pk_bf16_f32 v103, v54, v55
  v_fma_f32 v40, v40, s20, v22
  v_mfma_f32_16x16x32_bf16 v[204:207], a[172:175], v[120:123], v[204:207]
  v_exp_f32 v40, v40
  v_mfma_f32_16x16x32_bf16 v[236:239], a[172:175], v[124:127], v[236:239]
  v_fma_f32 v41, v41, s20, v22
  v_fma_f32 v42, v42, s20, v22
  v_mfma_f32_16x16x32_bf16 v[208:211], a[176:179], v[120:123], v[208:211]
  v_exp_f32 v41, v41
  v_fma_f32 v43, v43, s20, v22
  v_mfma_f32_16x16x32_bf16 v[240:243], a[176:179], v[124:127], v[240:243]
  v_exp_f32 v42, v42
  v_mfma_f32_16x16x32_bf16 v[212:215], a[180:183], v[120:123], v[212:215]
  v_exp_f32 v43, v43
  v_mfma_f32_16x16x32_bf16 v[244:247], a[180:183], v[124:127], v[244:247]
  v_cvt_pk_bf16_f32 v104, v40, v41
  v_cvt_pk_bf16_f32 v105, v42, v43
  v_fma_f32 v56, v56, s20, v22
  v_mfma_f32_16x16x32_bf16 v[216:219], a[184:187], v[120:123], v[216:219]
  v_exp_f32 v56, v56
  v_mfma_f32_16x16x32_bf16 v[248:251], a[184:187], v[124:127], v[248:251]
  v_fma_f32 v57, v57, s20, v22
  v_fma_f32 v58, v58, s20, v22
  v_mfma_f32_16x16x32_bf16 v[220:223], a[188:191], v[120:123], v[220:223]
  v_exp_f32 v57, v57
  v_fma_f32 v59, v59, s20, v22
  v_mfma_f32_16x16x32_bf16 v[252:255], a[188:191], v[124:127], v[252:255]
  s_waitcnt vmcnt(20) lgkmcnt(0)
  s_barrier
  v_mfma_f32_16x16x32_bf16 v[32:35], a[128:131], a[0:3], 0
  ds_read_b64_tr_b16 a[160:161], v4 offset:40960
  v_cvt_pk_bf16_f32 v106, v56, v57
  v_mfma_f32_16x16x32_bf16 v[32:35], a[132:135], a[4:7], v[32:35]
  v_exp_f32 v58, v58
  v_mfma_f32_16x16x32_bf16 v[32:35], a[136:139], a[8:11], v[32:35]
  ds_read_b64_tr_b16 a[162:163], v4 offset:45056
  v_fma_f32 v44, v44, s20, v23
  v_mfma_f32_16x16x32_bf16 v[32:35], a[140:143], a[12:15], v[32:35]
  s_add_u32 s16, s16, 0x2000
  s_and_b32 s16, s16, 0x1ffff
  v_mfma_f32_16x16x32_bf16 v[48:51], a[144:147], a[0:3], 0
  ds_read_b64_tr_b16 a[164:165], v5 offset:40960
  v_fma_f32 v45, v45, s20, v23
  v_mfma_f32_16x16x32_bf16 v[48:51], a[148:151], a[4:7], v[48:51]
  v_exp_f32 v59, v59
  s_add_u32 m0, s19, 0x6000
  v_mfma_f32_16x16x32_bf16 v[48:51], a[152:155], a[8:11], v[48:51]
  ds_read_b64_tr_b16 a[166:167], v5 offset:45056
  v_cvt_pk_bf16_f32 v107, v58, v59
  v_mfma_f32_16x16x32_bf16 v[48:51], a[156:159], a[12:15], v[48:51]
  buffer_load_dwordx4 v12, s[8:11], s16 offen offset:0 nt lds
  v_mfma_f32_16x16x32_bf16 v[36:39], a[128:131], a[16:19], 0
  ds_read_b64_tr_b16 a[168:169], v6 offset:40960
  v_fma_f32 v46, v46, s20, v23
  v_mfma_f32_16x16x32_bf16 v[36:39], a[132:135], a[20:23], v[36:39]
  v_exp_f32 v44, v44
  v_mfma_f32_16x16x32_bf16 v[36:39], a[136:139], a[24:27], v[36:39]
  ds_read_b64_tr_b16 a[170:171], v6 offset:45056
  v_fma_f32 v47, v47, s20, v23
  v_mfma_f32_16x16x32_bf16 v[36:39], a[140:143], a[28:31], v[36:39]
  buffer_load_dwordx4 v13, s[8:11], s16 offen offset:1024 nt lds
  v_mfma_f32_16x16x32_bf16 v[52:55], a[144:147], a[16:19], 0
  ds_read_b64_tr_b16 a[172:173], v7 offset:40960
  v_exp_f32 v45, v45
  v_mfma_f32_16x16x32_bf16 v[52:55], a[148:151], a[20:23], v[52:55]
  v_exp_f32 v46, v46
  v_mfma_f32_16x16x32_bf16 v[52:55], a[152:155], a[24:27], v[52:55]
  ds_read_b64_tr_b16 a[174:175], v7 offset:45056
  v_cvt_pk_bf16_f32 v108, v44, v45
  v_mfma_f32_16x16x32_bf16 v[52:55], a[156:159], a[28:31], v[52:55]
  buffer_load_dwordx4 v14, s[8:11], s16 offen offset:2048 nt lds
  v_fma_f32 v60, v60, s20, v23
  v_mfma_f32_16x16x32_bf16 v[40:43], a[128:131], a[32:35], 0
  ds_read_b64_tr_b16 a[176:177], v8 offset:40960
  v_fma_f32 v61, v61, s20, v23
  v_mfma_f32_16x16x32_bf16 v[40:43], a[132:135], a[36:39], v[40:43]
  v_exp_f32 v47, v47
  v_mfma_f32_16x16x32_bf16 v[40:43], a[136:139], a[40:43], v[40:43]
  ds_read_b64_tr_b16 a[178:179], v8 offset:45056
  v_cvt_pk_bf16_f32 v109, v46, v47
  v_fma_f32 v62, v62, s20, v23
  v_mfma_f32_16x16x32_bf16 v[40:43], a[140:143], a[44:47], v[40:43]
  buffer_load_dwordx4 v15, s[8:11], s16 offen offset:3072 nt lds
  v_mfma_f32_16x16x32_bf16 v[56:59], a[144:147], a[32:35], 0
  ds_read_b64_tr_b16 a[180:181], v9 offset:40960
  v_fma_f32 v63, v63, s20, v23
  v_mfma_f32_16x16x32_bf16 v[56:59], a[148:151], a[36:39], v[56:59]
  v_exp_f32 v60, v60
  v_fma_f32 v64, v64, s20, v20
  v_mfma_f32_16x16x32_bf16 v[56:59], a[152:155], a[40:43], v[56:59]
  ds_read_b64_tr_b16 a[182:183], v9 offset:45056
  v_fma_f32 v65, v65, s20, v20
  v_mfma_f32_16x16x32_bf16 v[56:59], a[156:159], a[44:47], v[56:59]
  v_exp_f32 v61, v61
  v_fma_f32 v66, v66, s20, v20
  v_mfma_f32_16x16x32_bf16 v[44:47], a[128:131], a[48:51], 0
  ds_read_b64_tr_b16 a[184:185], v10 offset:40960
  v_cvt_pk_bf16_f32 v110, v60, v61
  v_mfma_f32_16x16x32_bf16 v[44:47], a[132:135], a[52:55], v[44:47]
  v_exp_f32 v62, v62
  v_mfma_f32_16x16x32_bf16 v[44:47], a[136:139], a[56:59], v[44:47]
  ds_read_b64_tr_b16 a[186:187], v10 offset:45056
  v_exp_f32 v63, v63
  v_mfma_f32_16x16x32_bf16 v[44:47], a[140:143], a[60:63], v[44:47]
  v_exp_f32 v64, v64
  v_cvt_pk_bf16_f32 v111, v62, v63
  v_mfma_f32_16x16x32_bf16 v[60:63], a[144:147], a[48:51], 0
  ds_read_b64_tr_b16 a[188:189], v11 offset:40960
  v_fma_f32 v67, v67, s20, v20
  v_mfma_f32_16x16x32_bf16 v[60:63], a[148:151], a[52:55], v[60:63]
  v_exp_f32 v65, v65
  v_fma_f32 v80, v80, s20, v20
  v_mfma_f32_16x16x32_bf16 v[60:63], a[152:155], a[56:59], v[60:63]
  ds_read_b64_tr_b16 a[190:191], v11 offset:45056
  v_cvt_pk_bf16_f32 v112, v64, v65
  v_mfma_f32_16x16x32_bf16 v[60:63], a[156:159], a[60:63], v[60:63]
  v_exp_f32 v66, v66
  v_mfma_f32_16x16x32_bf16 a[96:99], a[100:103], v[96:99], a[96:99]
  v_exp_f32 v67, v67
  v_fma_f32 v81, v81, s20, v20
  v_mfma_f32_16x16x32_bf16 a[96:99], a[104:107], v[100:103], a[96:99]
  v_exp_f32 v80, v80
  v_mfma_f32_16x16x32_bf16 a[96:99], a[108:111], v[104:107], a[96:99]
  v_exp_f32 v81, v81
  v_mfma_f32_16x16x32_bf16 a[96:99], a[112:115], v[108:111], a[96:99]
  v_cvt_pk_bf16_f32 v113, v66, v67
  v_cvt_pk_bf16_f32 v114, v80, v81
  s_waitcnt lgkmcnt(1)
  v_mfma_f32_16x16x32_bf16 v[128:131], a[160:163], v[96:99], v[128:131]
  ds_read_b128 a[128:131], v0 offset:40960
  v_fma_f32 v82, v82, s20, v20
  v_mfma_f32_16x16x32_bf16 v[160:163], a[160:163], v[100:103], v[160:163]
  v_exp_f32 v82, v82
  v_fma_f32 v83, v83, s20, v20
  v_mfma_f32_16x16x32_bf16 v[132:135], a[164:167], v[96:99], v[132:135]
  ds_read_b128 a[132:135], v1 offset:40960
  v_fma_f32 v68, v68, s20, v21
  v_mfma_f32_16x16x32_bf16 v[164:167], a[164:167], v[100:103], v[164:167]
  v_exp_f32 v83, v83
  v_mfma_f32_16x16x32_bf16 v[136:139], a[168:171], v[96:99], v[136:139]
  ds_read_b128 a[136:139], v2 offset:40960
  v_cvt_pk_bf16_f32 v115, v82, v83
  v_fma_f32 v69, v69, s20, v21
  v_mfma_f32_16x16x32_bf16 v[168:171], a[168:171], v[100:103], v[168:171]
  v_exp_f32 v68, v68
  v_mfma_f32_16x16x32_bf16 v[140:143], a[172:175], v[96:99], v[140:143]
  ds_read_b128 a[140:143], v3 offset:40960
  v_fma_f32 v70, v70, s20, v21
  v_mfma_f32_16x16x32_bf16 v[172:175], a[172:175], v[100:103], v[172:175]
  v_exp_f32 v69, v69
  v_fma_f32 v71, v71, s20, v21
  v_mfma_f32_16x16x32_bf16 v[144:147], a[176:179], v[96:99], v[144:147]
  ds_read_b128 a[144:147], v0 offset:45056
  v_cvt_pk_bf16_f32 v116, v68, v69
  v_mfma_f32_16x16x32_bf16 v[176:179], a[176:179], v[100:103], v[176:179]
  v_exp_f32 v70, v70
  v_mfma_f32_16x16x32_bf16 v[148:151], a[180:183], v[96:99], v[148:151]
  ds_read_b128 a[148:151], v1 offset:45056
  v_exp_f32 v71, v71
  v_mfma_f32_16x16x32_bf16 v[180:183], a[180:183], v[100:103], v[180:183]
  v_fma_f32 v84, v84, s20, v21
  v_cvt_pk_bf16_f32 v117, v70, v71
  v_mfma_f32_16x16x32_bf16 v[152:155], a[184:187], v[96:99], v[152:155]
  ds_read_b128 a[152:155], v2 offset:45056
  v_fma_f32 v85, v85, s20, v21
  v_mfma_f32_16x16x32_bf16 v[184:187], a[184:187], v[100:103], v[184:187]
  v_exp_f32 v84, v84
  s_waitcnt lgkmcnt(3)
  v_mfma_f32_16x16x32_bf16 v[156:159], a[188:191], v[96:99], v[156:159]
  ds_read_b128 a[156:159], v3 offset:45056
  v_fma_f32 v86, v86, s20, v21
  v_mfma_f32_16x16x32_bf16 v[188:191], a[188:191], v[100:103], v[188:191]
  v_fma_f32 v87, v87, s20, v21
  s_add_u32 m0, s90, 0x2000
  v_mfma_f32_16x16x32_bf16 v[192:195], a[160:163], v[104:107], v[192:195]
  buffer_load_dwordx4 v16, s[4:7], s88 offen offset:0 nt lds
  v_fma_f32 v72, v72, s20, v22
  v_mfma_f32_16x16x32_bf16 v[224:227], a[160:163], v[108:111], v[224:227]
  v_exp_f32 v85, v85
  v_mfma_f32_16x16x32_bf16 v[196:199], a[164:167], v[104:107], v[196:199]
  v_exp_f32 v86, v86
  v_cvt_pk_bf16_f32 v118, v84, v85
  v_mfma_f32_16x16x32_bf16 v[228:231], a[164:167], v[108:111], v[228:231]
  v_exp_f32 v87, v87
  v_mfma_f32_16x16x32_bf16 v[200:203], a[168:171], v[104:107], v[200:203]
  v_exp_f32 v72, v72
  v_mfma_f32_16x16x32_bf16 v[232:235], a[168:171], v[108:111], v[232:235]
  v_cvt_pk_bf16_f32 v119, v86, v87
  v_fma_f32 v73, v73, s20, v22
  v_fma_f32 v74, v74, s20, v22
  v_mfma_f32_16x16x32_bf16 v[204:207], a[172:175], v[104:107], v[204:207]
  v_exp_f32 v73, v73
  v_mfma_f32_16x16x32_bf16 v[236:239], a[172:175], v[108:111], v[236:239]
  v_exp_f32 v74, v74
  v_mfma_f32_16x16x32_bf16 v[208:211], a[176:179], v[104:107], v[208:211]
  v_cvt_pk_bf16_f32 v120, v72, v73
  v_fma_f32 v75, v75, s20, v22
  v_fma_f32 v88, v88, s20, v22
  v_mfma_f32_16x16x32_bf16 v[240:243], a[176:179], v[108:111], v[240:243]
  v_exp_f32 v75, v75
  v_mfma_f32_16x16x32_bf16 v[212:215], a[180:183], v[104:107], v[212:215]
  buffer_store_dwordx4 a[196:199], v17, s[12:15], 0 offen offset:1024 nt
  v_mfma_f32_16x16x32_bf16 v[244:247], a[180:183], v[108:111], v[244:247]
  v_cvt_pk_bf16_f32 v121, v74, v75
  v_exp_f32 v88, v88
  v_mfma_f32_16x16x32_bf16 v[216:219], a[184:187], v[104:107], v[216:219]
  v_fma_f32 v89, v89, s20, v22
  v_fma_f32 v90, v90, s20, v22
  v_mfma_f32_16x16x32_bf16 v[248:251], a[184:187], v[108:111], v[248:251]
  v_exp_f32 v89, v89
  v_mfma_f32_16x16x32_bf16 v[220:223], a[188:191], v[104:107], v[220:223]
  v_exp_f32 v90, v90
  v_mfma_f32_16x16x32_bf16 v[252:255], a[188:191], v[108:111], v[252:255]
  s_waitcnt vmcnt(20) lgkmcnt(0)
  s_barrier
  v_mfma_f32_16x16x32_bf16 v[64:67], a[128:131], a[0:3], 0
  ds_read_b64_tr_b16 a[160:161], v4 offset:0
  v_cvt_pk_bf16_f32 v122, v88, v89
  v_mfma_f32_16x16x32_bf16 v[64:67], a[132:135], a[4:7], v[64:67]
  v_fma_f32 v91, v91, s20, v22
  v_fma_f32 v76, v76, s20, v23
  v_mfma_f32_16x16x32_bf16 v[64:67], a[136:139], a[8:11], v[64:67]
  ds_read_b64_tr_b16 a[162:163], v4 offset:4096
  v_fma_f32 v77, v77, s20, v23
  v_mfma_f32_16x16x32_bf16 v[64:67], a[140:143], a[12:15], v[64:67]
  s_add_u32 s16, s16, 0x2000
  s_and_b32 s16, s16, 0x1ffff
  v_mfma_f32_16x16x32_bf16 v[80:83], a[144:147], a[0:3], 0
  ds_read_b64_tr_b16 a[164:165], v5 offset:0
  v_fma_f32 v78, v78, s20, v23
  v_mfma_f32_16x16x32_bf16 v[80:83], a[148:151], a[4:7], v[80:83]
  v_fma_f32 v79, v79, s20, v23
  s_add_u32 m0, s19, 0x8000
  v_mfma_f32_16x16x32_bf16 v[80:83], a[152:155], a[8:11], v[80:83]
  ds_read_b64_tr_b16 a[166:167], v5 offset:4096
  v_fma_f32 v92, v92, s20, v23
  v_mfma_f32_16x16x32_bf16 v[80:83], a[156:159], a[12:15], v[80:83]
  buffer_load_dwordx4 v12, s[8:11], s16 offen offset:0 nt lds
  v_mfma_f32_16x16x32_bf16 v[68:71], a[128:131], a[16:19], 0
  ds_read_b64_tr_b16 a[168:169], v6 offset:0
  v_fma_f32 v93, v93, s20, v23
  v_mfma_f32_16x16x32_bf16 v[68:71], a[132:135], a[20:23], v[68:71]
  v_exp_f32 v91, v91
  v_mfma_f32_16x16x32_bf16 v[68:71], a[136:139], a[24:27], v[68:71]
  ds_read_b64_tr_b16 a[170:171], v6 offset:4096
  v_cvt_pk_bf16_f32 v123, v90, v91
  v_fma_f32 v94, v94, s20, v23
  v_mfma_f32_16x16x32_bf16 v[68:71], a[140:143], a[28:31], v[68:71]
  buffer_load_dwordx4 v13, s[8:11], s16 offen offset:1024 nt lds
  v_mfma_f32_16x16x32_bf16 v[84:87], a[144:147], a[16:19], 0
  ds_read_b64_tr_b16 a[172:173], v7 offset:0
  v_fma_f32 v95, v95, s20, v23
  v_mfma_f32_16x16x32_bf16 v[84:87], a[148:151], a[20:23], v[84:87]
  v_exp_f32 v76, v76
  v_mfma_f32_16x16x32_bf16 v[84:87], a[152:155], a[24:27], v[84:87]
  ds_read_b64_tr_b16 a[174:175], v7 offset:4096
  v_fma_f32 v32, v32, s20, v20
  v_mfma_f32_16x16x32_bf16 v[84:87], a[156:159], a[28:31], v[84:87]
  buffer_load_dwordx4 v14, s[8:11], s16 offen offset:2048 nt lds
  v_fma_f32 v33, v33, s20, v20
  v_mfma_f32_16x16x32_bf16 v[72:75], a[128:131], a[32:35], 0
  ds_read_b64_tr_b16 a[176:177], v8 offset:0
  v_fma_f32 v34, v34, s20, v20
  v_mfma_f32_16x16x32_bf16 v[72:75], a[132:135], a[36:39], v[72:75]
  v_exp_f32 v77, v77
  v_mfma_f32_16x16x32_bf16 v[72:75], a[136:139], a[40:43], v[72:75]
  ds_read_b64_tr_b16 a[178:179], v8 offset:4096
  v_exp_f32 v78, v78
  v_mfma_f32_16x16x32_bf16 v[72:75], a[140:143], a[44:47], v[72:75]
  buffer_load_dwordx4 v15, s[8:11], s16 offen offset:3072 nt lds
  v_mfma_f32_16x16x32_bf16 v[88:91], a[144:147], a[32:35], 0
  ds_read_b64_tr_b16 a[180:181], v9 offset:0
  v_cvt_pk_bf16_f32 v124, v76, v77
  v_mfma_f32_16x16x32_bf16 v[88:91], a[148:151], a[36:39], v[88:91]
  v_exp_f32 v79, v79
  v_fma_f32 v35, v35, s20, v20
  v_mfma_f32_16x16x32_bf16 v[88:91], a[152:155], a[40:43], v[88:91]
  ds_read_b64_tr_b16 a[182:183], v9 offset:4096
  v_cvt_pk_bf16_f32 v125, v78, v79
  v_mfma_f32_16x16x32_bf16 v[88:91], a[156:159], a[44:47], v[88:91]
  v_exp_f32 v92, v92
  v_mfma_f32_16x16x32_bf16 v[76:79], a[128:131], a[48:51], 0
  ds_read_b64_tr_b16 a[184:185], v10 offset:0
  v_exp_f32 v93, v93
  v_mfma_f32_16x16x32_bf16 v[76:79], a[132:135], a[52:55], v[76:79]
  v_exp_f32 v94, v94
  v_mfma_f32_16x16x32_bf16 v[76:79], a[136:139], a[56:59], v[76:79]
  ds_read_b64_tr_b16 a[186:187], v10 offset:4096
  v_exp_f32 v95, v95
  v_mfma_f32_16x16x32_bf16 v[76:79], a[140:143], a[60:63], v[76:79]
  v_exp_f32 v32, v32
  v_cvt_pk_bf16_f32 v126, v92, v93
  v_cvt_pk_bf16_f32 v127, v94, v95
  v_mfma_f32_16x16x32_bf16 v[92:95], a[144:147], a[48:51], 0
  ds_read_b64_tr_b16 a[188:189], v11 offset:0
  v_fma_f32 v48, v48, s20, v20
  v_mfma_f32_16x16x32_bf16 v[92:95], a[148:151], a[52:55], v[92:95]
  v_exp_f32 v33, v33
  v_mfma_f32_16x16x32_bf16 v[92:95], a[152:155], a[56:59], v[92:95]
  ds_read_b64_tr_b16 a[190:191], v11 offset:4096
  v_exp_f32 v34, v34
  v_mfma_f32_16x16x32_bf16 v[92:95], a[156:159], a[60:63], v[92:95]
  v_exp_f32 v35, v35
  v_mfma_f32_16x16x32_bf16 a[96:99], a[100:103], v[112:115], a[96:99]
  v_exp_f32 v48, v48
  v_mfma_f32_16x16x32_bf16 a[96:99], a[104:107], v[116:119], a[96:99]
  v_cvt_pk_bf16_f32 v96, v32, v33
  v_cvt_pk_bf16_f32 v97, v34, v35
  v_fma_f32 v49, v49, s20, v20
  v_mfma_f32_16x16x32_bf16 a[96:99], a[108:111], v[120:123], a[96:99]
  v_exp_f32 v49, v49
  v_mfma_f32_16x16x32_bf16 a[96:99], a[112:115], v[124:127], a[96:99]
  v_fma_f32 v50, v50, s20, v20
  s_waitcnt lgkmcnt(1)
  v_mfma_f32_16x16x32_bf16 v[128:131], a[160:163], v[112:115], v[128:131]
  ds_read_b128 a[128:131], v0 offset:0
  v_cvt_pk_bf16_f32 v98, v48, v49
  v_mfma_f32_16x16x32_bf16 v[160:163], a[160:163], v[116:119], v[160:163]
  v_exp_f32 v50, v50
  v_fma_f32 v51, v51, s20, v20
  v_mfma_f32_16x16x32_bf16 v[132:135], a[164:167], v[112:115], v[132:135]
  ds_read_b128 a[132:135], v1 offset:0
  v_fma_f32 v36, v36, s20, v21
  v_mfma_f32_16x16x32_bf16 v[164:167], a[164:167], v[116:119], v[164:167]
  v_exp_f32 v51, v51
  v_mfma_f32_16x16x32_bf16 v[136:139], a[168:171], v[112:115], v[136:139]
  ds_read_b128 a[136:139], v2 offset:0
  v_cvt_pk_bf16_f32 v99, v50, v51
  v_fma_f32 v37, v37, s20, v21
  v_mfma_f32_16x16x32_bf16 v[168:171], a[168:171], v[116:119], v[168:171]
  v_exp_f32 v36, v36
  v_mfma_f32_16x16x32_bf16 v[140:143], a[172:175], v[112:115], v[140:143]
  ds_read_b128 a[140:143], v3 offset:0
  v_fma_f32 v38, v38, s20, v21
  v_mfma_f32_16x16x32_bf16 v[172:175], a[172:175], v[116:119], v[172:175]
  v_exp_f32 v37, v37
  v_mfma_f32_16x16x32_bf16 v[144:147], a[176:179], v[112:115], v[144:147]
  ds_read_b128 a[144:147], v0 offset:4096
  v_exp_f32 v38, v38
  v_mfma_f32_16x16x32_bf16 v[176:179], a[176:179], v[116:119], v[176:179]
  v_cvt_pk_bf16_f32 v100, v36, v37
  v_fma_f32 v39, v39, s20, v21
  v_mfma_f32_16x16x32_bf16 v[148:151], a[180:183], v[112:115], v[148:151]
  ds_read_b128 a[148:151], v1 offset:4096
  v_fma_f32 v52, v52, s20, v21
  v_mfma_f32_16x16x32_bf16 v[180:183], a[180:183], v[116:119], v[180:183]
  v_exp_f32 v39, v39
  v_fma_f32 v53, v53, s20, v21
  v_mfma_f32_16x16x32_bf16 v[152:155], a[184:187], v[112:115], v[152:155]
  ds_read_b128 a[152:155], v2 offset:4096
  v_cvt_pk_bf16_f32 v101, v38, v39
  v_mfma_f32_16x16x32_bf16 v[184:187], a[184:187], v[116:119], v[184:187]
  v_fma_f32 v54, v54, s20, v21
  s_waitcnt lgkmcnt(3)
  v_mfma_f32_16x16x32_bf16 v[156:159], a[188:191], v[112:115], v[156:159]
  ds_read_b128 a[156:159], v3 offset:4096
  v_fma_f32 v55, v55, s20, v21
  v_mfma_f32_16x16x32_bf16 v[188:191], a[188:191], v[116:119], v[188:191]
  v_exp_f32 v52, v52
  s_add_u32 m0, s90, 0x2000
  v_mfma_f32_16x16x32_bf16 v[192:195], a[160:163], v[120:123], v[192:195]
  buffer_load_dwordx4 v17, s[4:7], s88 offen offset:1024 nt lds
  v_mfma_f32_16x16x32_bf16 v[224:227], a[160:163], v[124:127], v[224:227]
  v_exp_f32 v53, v53
  v_mfma_f32_16x16x32_bf16 v[196:199], a[164:167], v[120:123], v[196:199]
  v_exp_f32 v54, v54
  v_mfma_f32_16x16x32_bf16 v[228:231], a[164:167], v[124:127], v[228:231]
  v_exp_f32 v55, v55
  v_cvt_pk_bf16_f32 v102, v52, v53
  v_mfma_f32_16x16x32_bf16 v[200:203], a[168:171], v[120:123], v[200:203]
  buffer_load_dwordx4 v18, s[4:7], s88 offen offset:2048 nt lds
  v_mfma_f32_16x16x32_bf16 v[232:235], a[168:171], v[124:127], v[232:235]
  v_cvt_pk_bf16_f32 v103, v54, v55
  v_fma_f32 v40, v40, s20, v22
  v_mfma_f32_16x16x32_bf16 v[204:207], a[172:175], v[120:123], v[204:207]
  v_exp_f32 v40, v40
  v_fma_f32 v41, v41, s20, v22
  v_mfma_f32_16x16x32_bf16 v[236:239], a[172:175], v[124:127], v[236:239]
  v_exp_f32 v41, v41
  v_mfma_f32_16x16x32_bf16 v[208:211], a[176:179], v[120:123], v[208:211]
  v_fma_f32 v42, v42, s20, v22
  v_cvt_pk_bf16_f32 v104, v40, v41
  v_mfma_f32_16x16x32_bf16 v[240:243], a[176:179], v[124:127], v[240:243]
  v_exp_f32 v42, v42
  v_mfma_f32_16x16x32_bf16 v[212:215], a[180:183], v[120:123], v[212:215]
  v_fma_f32 v43, v43, s20, v22
  v_fma_f32 v56, v56, s20, v22
  v_fma_f32 v57, v57, s20, v22
  v_mfma_f32_16x16x32_bf16 v[244:247], a[180:183], v[124:127], v[244:247]
  v_exp_f32 v43, v43
  v_mfma_f32_16x16x32_bf16 v[216:219], a[184:187], v[120:123], v[216:219]
  v_exp_f32 v56, v56
  v_mfma_f32_16x16x32_bf16 v[248:251], a[184:187], v[124:127], v[248:251]
  v_cvt_pk_bf16_f32 v105, v42, v43
  v_exp_f32 v57, v57
  v_mfma_f32_16x16x32_bf16 v[220:223], a[188:191], v[120:123], v[220:223]
  v_fma_f32 v58, v58, s20, v22
  v_cvt_pk_bf16_f32 v106, v56, v57
  v_mfma_f32_16x16x32_bf16 v[252:255], a[188:191], v[124:127], v[252:255]
  s_waitcnt vmcnt(20) lgkmcnt(0)
  s_barrier
  v_mfma_f32_16x16x32_bf16 v[32:35], a[128:131], a[0:3], 0
  ds_read_b64_tr_b16 a[160:161], v4 offset:8192
  v_fma_f32 v59, v59, s20, v22
  v_mfma_f32_16x16x32_bf16 v[32:35], a[132:135], a[4:7], v[32:35]
  v_exp_f32 v58, v58
  v_mfma_f32_16x16x32_bf16 v[32:35], a[136:139], a[8:11], v[32:35]
  ds_read_b64_tr_b16 a[162:163], v4 offset:12288
  v_fma_f32 v44, v44, s20, v23
  v_mfma_f32_16x16x32_bf16 v[32:35], a[140:143], a[12:15], v[32:35]
  v_fma_f32 v45, v45, s20, v23
  s_add_u32 s16, s16, 0x2000
  s_and_b32 s16, s16, 0x1ffff
  v_mfma_f32_16x16x32_bf16 v[48:51], a[144:147], a[0:3], 0
  ds_read_b64_tr_b16 a[164:165], v5 offset:8192
  v_fma_f32 v46, v46, s20, v23
  v_mfma_f32_16x16x32_bf16 v[48:51], a[148:151], a[4:7], v[48:51]
  v_fma_f32 v47, v47, s20, v23
  s_add_u32 m0, s19, 0xa000
  v_mfma_f32_16x16x32_bf16 v[48:51], a[152:155], a[8:11], v[48:51]
  ds_read_b64_tr_b16 a[166:167], v5 offset:12288
  v_fma_f32 v60, v60, s20, v23
  v_mfma_f32_16x16x32_bf16 v[48:51], a[156:159], a[12:15], v[48:51]
  buffer_load_dwordx4 v12, s[8:11], s16 offen offset:0 nt lds
  v_mfma_f32_16x16x32_bf16 v[36:39], a[128:131], a[16:19], 0
  ds_read_b64_tr_b16 a[168:169], v6 offset:8192
  v_fma_f32 v61, v61, s20, v23
  v_mfma_f32_16x16x32_bf16 v[36:39], a[132:135], a[20:23], v[36:39]
  v_exp_f32 v59, v59
  v_mfma_f32_16x16x32_bf16 v[36:39], a[136:139], a[24:27], v[36:39]
  ds_read_b64_tr_b16 a[170:171], v6 offset:12288
  v_cvt_pk_bf16_f32 v107, v58, v59
  v_fma_f32 v62, v62, s20, v23
  v_mfma_f32_16x16x32_bf16 v[36:39], a[140:143], a[28:31], v[36:39]
  buffer_load_dwordx4 v13, s[8:11], s16 offen offset:1024 nt lds
  v_mfma_f32_16x16x32_bf16 v[52:55], a[144:147], a[16:19], 0
  ds_read_b64_tr_b16 a[172:173], v7 offset:8192
  v_fma_f32 v63, v63, s20, v23
  v_mfma_f32_16x16x32_bf16 v[52:55], a[148:151], a[20:23], v[52:55]
  v_exp_f32 v44, v44
  v_fma_f32 v64, v64, s20, v20
  v_mfma_f32_16x16x32_bf16 v[52:55], a[152:155], a[24:27], v[52:55]
  ds_read_b64_tr_b16 a[174:175], v7 offset:12288
  v_fma_f32 v65, v65, s20, v20
  v_mfma_f32_16x16x32_bf16 v[52:55], a[156:159], a[28:31], v[52:55]
  buffer_load_dwordx4 v14, s[8:11], s16 offen offset:2048 nt lds
  v_mfma_f32_16x16x32_bf16 v[40:43], a[128:131], a[32:35], 0
  ds_read_b64_tr_b16 a[176:177], v8 offset:8192
  v_exp_f32 v45, v45
  v_mfma_f32_16x16x32_bf16 v[40:43], a[132:135], a[36:39], v[40:43]
  v_exp_f32 v46, v46
  v_mfma_f32_16x16x32_bf16 v[40:43], a[136:139], a[40:43], v[40:43]
  ds_read_b64_tr_b16 a[178:179], v8 offset:12288
  v_cvt_pk_bf16_f32 v108, v44, v45
  v_mfma_f32_16x16x32_bf16 v[40:43], a[140:143], a[44:47], v[40:43]
  buffer_load_dwordx4 v15, s[8:11], s16 offen offset:3072 nt lds
  v_fma_f32 v66, v66, s20, v20
  v_mfma_f32_16x16x32_bf16 v[56:59], a[144:147], a[32:35], 0
  ds_read_b64_tr_b16 a[180:181], v9 offset:8192
  v_fma_f32 v67, v67, s20, v20
  v_mfma_f32_16x16x32_bf16 v[56:59], a[148:151], a[36:39], v[56:59]
  v_exp_f32 v47, v47
  v_fma_f32 v80, v80, s20, v20
  v_mfma_f32_16x16x32_bf16 v[56:59], a[152:155], a[40:43], v[56:59]
  ds_read_b64_tr_b16 a[182:183], v9 offset:12288
  v_cvt_pk_bf16_f32 v109, v46, v47
  v_mfma_f32_16x16x32_bf16 v[56:59], a[156:159], a[44:47], v[56:59]
  v_exp_f32 v60, v60
  v_mfma_f32_16x16x32_bf16 v[44:47], a[128:131], a[48:51], 0
  ds_read_b64_tr_b16 a[184:185], v10 offset:8192
  v_exp_f32 v61, v61
  v_mfma_f32_16x16x32_bf16 v[44:47], a[132:135], a[52:55], v[44:47]
  v_exp_f32 v62, v62
  v_mfma_f32_16x16x32_bf16 v[44:47], a[136:139], a[56:59], v[44:47]
  ds_read_b64_tr_b16 a[186:187], v10 offset:12288
  v_exp_f32 v63, v63
  v_mfma_f32_16x16x32_bf16 v[44:47], a[140:143], a[60:63], v[44:47]
  v_exp_f32 v64, v64
  v_cvt_pk_bf16_f32 v110, v60, v61
  v_cvt_pk_bf16_f32 v111, v62, v63
  v_mfma_f32_16x16x32_bf16 v[60:63], a[144:147], a[48:51], 0
  ds_read_b64_tr_b16 a[188:189], v11 offset:8192
  v_fma_f32 v81, v81, s20, v20
  v_mfma_f32_16x16x32_bf16 v[60:63], a[148:151], a[52:55], v[60:63]
  v_exp_f32 v65, v65
  v_fma_f32 v82, v82, s20, v20
  v_mfma_f32_16x16x32_bf16 v[60:63], a[152:155], a[56:59], v[60:63]
  ds_read_b64_tr_b16 a[190:191], v11 offset:12288
  v_cvt_pk_bf16_f32 v112, v64, v65
  v_mfma_f32_16x16x32_bf16 v[60:63], a[156:159], a[60:63], v[60:63]
  v_exp_f32 v66, v66
  v_fma_f32 v83, v83, s20, v20
  v_mfma_f32_16x16x32_bf16 a[96:99], a[100:103], v[96:99], a[96:99]
  v_exp_f32 v67, v67
  v_mfma_f32_16x16x32_bf16 a[96:99], a[104:107], v[100:103], a[96:99]
  v_exp_f32 v80, v80
  v_mfma_f32_16x16x32_bf16 a[96:99], a[108:111], v[104:107], a[96:99]
  v_cvt_pk_bf16_f32 v113, v66, v67
  v_exp_f32 v81, v81
  v_mfma_f32_16x16x32_bf16 a[96:99], a[112:115], v[108:111], a[96:99]
  v_fma_f32 v68, v68, s20, v21
  s_waitcnt lgkmcnt(1)
  v_mfma_f32_16x16x32_bf16 v[128:131], a[160:163], v[96:99], v[128:131]
  ds_read_b128 a[128:131], v0 offset:8192
  v_cvt_pk_bf16_f32 v114, v80, v81
  v_mfma_f32_16x16x32_bf16 v[160:163], a[160:163], v[100:103], v[160:163]
  v_exp_f32 v82, v82
  v_fma_f32 v69, v69, s20, v21
  v_mfma_f32_16x16x32_bf16 v[132:135], a[164:167], v[96:99], v[132:135]
  ds_read_b128 a[132:135], v1 offset:8192
  v_fma_f32 v70, v70, s20, v21
  v_mfma_f32_16x16x32_bf16 v[164:167], a[164:167], v[100:103], v[164:167]
  v_exp_f32 v83, v83
  v_fma_f32 v71, v71, s20, v21
  v_mfma_f32_16x16x32_bf16 v[136:139], a[168:171], v[96:99], v[136:139]
  ds_read_b128 a[136:139], v2 offset:8192
  v_cvt_pk_bf16_f32 v115, v82, v83
  v_mfma_f32_16x16x32_bf16 v[168:171], a[168:171], v[100:103], v[168:171]
  v_exp_f32 v68, v68
  v_mfma_f32_16x16x32_bf16 v[140:143], a[172:175], v[96:99], v[140:143]
  ds_read_b128 a[140:143], v3 offset:8192
  v_exp_f32 v69, v69
  v_mfma_f32_16x16x32_bf16 v[172:175], a[172:175], v[100:103], v[172:175]
  v_exp_f32 v70, v70
  v_mfma_f32_16x16x32_bf16 v[144:147], a[176:179], v[96:99], v[144:147]
  ds_read_b128 a[144:147], v0 offset:12288
  v_cvt_pk_bf16_f32 v116, v68, v69
  v_mfma_f32_16x16x32_bf16 v[176:179], a[176:179], v[100:103], v[176:179]
  v_exp_f32 v71, v71
  v_fma_f32 v84, v84, s20, v21
  v_mfma_f32_16x16x32_bf16 v[148:151], a[180:183], v[96:99], v[148:151]
  ds_read_b128 a[148:151], v1 offset:12288
  v_cvt_pk_bf16_f32 v117, v70, v71
  v_mfma_f32_16x16x32_bf16 v[180:183], a[180:183], v[100:103], v[180:183]
  v_exp_f32 v84, v84
  v_mfma_f32_16x16x32_bf16 v[152:155], a[184:187], v[96:99], v[152:155]
  ds_read_b128 a[152:155], v2 offset:12288
  v_fma_f32 v85, v85, s20, v21
  v_fma_f32 v86, v86, s20, v21
  v_mfma_f32_16x16x32_bf16 v[184:187], a[184:187], v[100:103], v[184:187]
  v_fma_f32 v87, v87, s20, v21
  s_waitcnt lgkmcnt(3)
  v_mfma_f32_16x16x32_bf16 v[156:159], a[188:191], v[96:99], v[156:159]
  ds_read_b128 a[156:159], v3 offset:12288
  v_exp_f32 v85, v85
  v_mfma_f32_16x16x32_bf16 v[188:191], a[188:191], v[100:103], v[188:191]
  v_fma_f32 v72, v72, s20, v22
  s_add_u32 m0, s90, 0x2000
  v_mfma_f32_16x16x32_bf16 v[192:195], a[160:163], v[104:107], v[192:195]
  buffer_load_dwordx4 v19, s[4:7], s88 offen offset:3072 nt lds
  v_mfma_f32_16x16x32_bf16 v[224:227], a[160:163], v[108:111], v[224:227]
  v_exp_f32 v86, v86
  v_cvt_pk_bf16_f32 v118, v84, v85
  v_mfma_f32_16x16x32_bf16 v[196:199], a[164:167], v[104:107], v[196:199]
  v_exp_f32 v87, v87
  v_mfma_f32_16x16x32_bf16 v[228:231], a[164:167], v[108:111], v[228:231]
  v_exp_f32 v72, v72
  v_mfma_f32_16x16x32_bf16 v[200:203], a[168:171], v[104:107], v[200:203]
  v_cvt_pk_bf16_f32 v119, v86, v87
  v_fma_f32 v73, v73, s20, v22
  v_fma_f32 v74, v74, s20, v22
  v_mfma_f32_16x16x32_bf16 v[232:235], a[168:171], v[108:111], v[232:235]
  v_exp_f32 v73, v73
  v_mfma_f32_16x16x32_bf16 v[204:207], a[172:175], v[104:107], v[204:207]
  v_exp_f32 v74, v74
  v_mfma_f32_16x16x32_bf16 v[236:239], a[172:175], v[108:111], v[236:239]
  v_cvt_pk_bf16_f32 v120, v72, v73
  v_fma_f32 v75, v75, s20, v22
  v_fma_f32 v88, v88, s20, v22
  v_mfma_f32_16x16x32_bf16 v[208:211], a[176:179], v[104:107], v[208:211]
  v_exp_f32 v75, v75
  v_mfma_f32_16x16x32_bf16 v[240:243], a[176:179], v[108:111], v[240:243]
  v_exp_f32 v88, v88
  v_cvt_pk_bf16_f32 v121, v74, v75
  v_mfma_f32_16x16x32_bf16 v[212:215], a[180:183], v[104:107], v[212:215]
  buffer_store_dwordx4 a[200:203], v18, s[12:15], 0 offen offset:2048 nt
  v_mfma_f32_16x16x32_bf16 v[244:247], a[180:183], v[108:111], v[244:247]
  v_fma_f32 v89, v89, s20, v22
  v_fma_f32 v90, v90, s20, v22
  v_mfma_f32_16x16x32_bf16 v[216:219], a[184:187], v[104:107], v[216:219]
  v_exp_f32 v89, v89
  v_mfma_f32_16x16x32_bf16 v[248:251], a[184:187], v[108:111], v[248:251]
  v_exp_f32 v90, v90
  v_cvt_pk_bf16_f32 v122, v88, v89
  v_mfma_f32_16x16x32_bf16 v[220:223], a[188:191], v[104:107], v[220:223]
  v_fma_f32 v91, v91, s20, v22
  v_fma_f32 v76, v76, s20, v23
  v_mfma_f32_16x16x32_bf16 v[252:255], a[188:191], v[108:111], v[252:255]
  s_waitcnt vmcnt(20) lgkmcnt(0)
  s_barrier
  v_mfma_f32_16x16x32_bf16 v[64:67], a[128:131], a[0:3], 0
  ds_read_b64_tr_b16 a[160:161], v4 offset:16384
  v_fma_f32 v77, v77, s20, v23
  v_mfma_f32_16x16x32_bf16 v[64:67], a[132:135], a[4:7], v[64:67]
  s_mov_b32 s10, s22
  s_add_u32 s8, s8, s17
  s_addc_u32 s9, s9, 0
  v_mfma_f32_16x16x32_bf16 v[64:67], a[136:139], a[8:11], v[64:67]
  ds_read_b64_tr_b16 a[162:163], v4 offset:20480
  v_fma_f32 v78, v78, s20, v23
  v_mfma_f32_16x16x32_bf16 v[64:67], a[140:143], a[12:15], v[64:67]
  s_add_u32 s16, s16, 0x2000
  s_and_b32 s16, s16, 0x1ffff
  v_mfma_f32_16x16x32_bf16 v[80:83], a[144:147], a[0:3], 0
  ds_read_b64_tr_b16 a[164:165], v5 offset:16384
  v_fma_f32 v79, v79, s20, v23
  v_mfma_f32_16x16x32_bf16 v[80:83], a[148:151], a[4:7], v[80:83]
  v_fma_f32 v92, v92, s20, v23
  s_add_u32 m0, s19, 0x0
  v_mfma_f32_16x16x32_bf16 v[80:83], a[152:155], a[8:11], v[80:83]
  ds_read_b64_tr_b16 a[166:167], v5 offset:20480
  v_fma_f32 v93, v93, s20, v23
  v_mfma_f32_16x16x32_bf16 v[80:83], a[156:159], a[12:15], v[80:83]
  buffer_load_dwordx4 v12, s[8:11], s16 offen offset:0 nt lds
  v_fma_f32 v94, v94, s20, v23
  v_mfma_f32_16x16x32_bf16 v[68:71], a[128:131], a[16:19], 0
  ds_read_b64_tr_b16 a[168:169], v6 offset:16384
  v_fma_f32 v95, v95, s20, v23
  v_mfma_f32_16x16x32_bf16 v[68:71], a[132:135], a[20:23], v[68:71]
  v_exp_f32 v91, v91
  v_mfma_f32_16x16x32_bf16 v[68:71], a[136:139], a[24:27], v[68:71]
  ds_read_b64_tr_b16 a[170:171], v6 offset:20480
  v_cvt_pk_bf16_f32 v123, v90, v91
  v_mfma_f32_16x16x32_bf16 v[68:71], a[140:143], a[28:31], v[68:71]
  buffer_load_dwordx4 v13, s[8:11], s16 offen offset:1024 nt lds
  v_mfma_f32_16x16x32_bf16 v[84:87], a[144:147], a[16:19], 0
  ds_read_b64_tr_b16 a[172:173], v7 offset:16384
  v_fma_f32 v32, v32, s20, v20
  v_mfma_f32_16x16x32_bf16 v[84:87], a[148:151], a[20:23], v[84:87]
  v_exp_f32 v76, v76
  v_mfma_f32_16x16x32_bf16 v[84:87], a[152:155], a[24:27], v[84:87]
  ds_read_b64_tr_b16 a[174:175], v7 offset:20480
  v_exp_f32 v77, v77
  v_mfma_f32_16x16x32_bf16 v[84:87], a[156:159], a[28:31], v[84:87]
  buffer_load_dwordx4 v14, s[8:11], s16 offen offset:2048 nt lds
  v_mfma_f32_16x16x32_bf16 v[72:75], a[128:131], a[32:35], 0
  ds_read_b64_tr_b16 a[176:177], v8 offset:16384
  v_cvt_pk_bf16_f32 v124, v76, v77
  v_mfma_f32_16x16x32_bf16 v[72:75], a[132:135], a[36:39], v[72:75]
  v_exp_f32 v78, v78
  v_mfma_f32_16x16x32_bf16 v[72:75], a[136:139], a[40:43], v[72:75]
  ds_read_b64_tr_b16 a[178:179], v8 offset:20480
  v_exp_f32 v79, v79
  v_mfma_f32_16x16x32_bf16 v[72:75], a[140:143], a[44:47], v[72:75]
  buffer_load_dwordx4 v15, s[8:11], s16 offen offset:3072 nt lds
  v_mfma_f32_16x16x32_bf16 v[88:91], a[144:147], a[32:35], 0
  ds_read_b64_tr_b16 a[180:181], v9 offset:16384
  v_cvt_pk_bf16_f32 v125, v78, v79
  v_mfma_f32_16x16x32_bf16 v[88:91], a[148:151], a[36:39], v[88:91]
  v_exp_f32 v92, v92
  v_fma_f32 v33, v33, s20, v20
  v_mfma_f32_16x16x32_bf16 v[88:91], a[152:155], a[40:43], v[88:91]
  ds_read_b64_tr_b16 a[182:183], v9 offset:20480
  v_fma_f32 v34, v34, s20, v20
  v_mfma_f32_16x16x32_bf16 v[88:91], a[156:159], a[44:47], v[88:91]
  v_exp_f32 v93, v93
  v_mfma_f32_16x16x32_bf16 v[76:79], a[128:131], a[48:51], 0
  ds_read_b64_tr_b16 a[184:185], v10 offset:16384
  v_exp_f32 v94, v94
  v_mfma_f32_16x16x32_bf16 v[76:79], a[132:135], a[52:55], v[76:79]
  v_exp_f32 v95, v95
  v_mfma_f32_16x16x32_bf16 v[76:79], a[136:139], a[56:59], v[76:79]
  ds_read_b64_tr_b16 a[186:187], v10 offset:20480
  v_cvt_pk_bf16_f32 v126, v92, v93
  v_mfma_f32_16x16x32_bf16 v[76:79], a[140:143], a[60:63], v[76:79]
  v_exp_f32 v32, v32
  v_cvt_pk_bf16_f32 v127, v94, v95
  v_mfma_f32_16x16x32_bf16 v[92:95], a[144:147], a[48:51], 0
  ds_read_b64_tr_b16 a[188:189], v11 offset:16384
  v_exp_f32 v33, v33
  v_mfma_f32_16x16x32_bf16 v[92:95], a[148:151], a[52:55], v[92:95]
  v_exp_f32 v34, v34
  v_mfma_f32_16x16x32_bf16 v[92:95], a[152:155], a[56:59], v[92:95]
  ds_read_b64_tr_b16 a[190:191], v11 offset:20480
  v_cvt_pk_bf16_f32 v96, v32, v33
  v_mfma_f32_16x16x32_bf16 v[92:95], a[156:159], a[60:63], v[92:95]
  v_fma_f32 v35, v35, s20, v20
  v_fma_f32 v48, v48, s20, v20
  v_fma_f32 v49, v49, s20, v20
  v_mfma_f32_16x16x32_bf16 a[96:99], a[100:103], v[112:115], a[96:99]
  v_exp_f32 v35, v35
  v_mfma_f32_16x16x32_bf16 a[96:99], a[104:107], v[116:119], a[96:99]
  v_exp_f32 v48, v48
  v_mfma_f32_16x16x32_bf16 a[96:99], a[108:111], v[120:123], a[96:99]
  v_exp_f32 v49, v49
  v_mfma_f32_16x16x32_bf16 a[96:99], a[112:115], v[124:127], a[96:99]
  v_cvt_pk_bf16_f32 v97, v34, v35
  v_cvt_pk_bf16_f32 v98, v48, v49
  s_waitcnt lgkmcnt(1)
  v_mfma_f32_16x16x32_bf16 v[128:131], a[160:163], v[112:115], v[128:131]
  ds_read_b128 a[128:131], v0 offset:16384
  v_fma_f32 v50, v50, s20, v20
  v_mfma_f32_16x16x32_bf16 v[160:163], a[160:163], v[116:119], v[160:163]
  v_exp_f32 v50, v50
  v_mfma_f32_16x16x32_bf16 v[132:135], a[164:167], v[112:115], v[132:135]
  ds_read_b128 a[132:135], v1 offset:16384
  v_fma_f32 v51, v51, s20, v20
  v_fma_f32 v36, v36, s20, v21
  v_mfma_f32_16x16x32_bf16 v[164:167], a[164:167], v[116:119], v[164:167]
  v_exp_f32 v51, v51
  v_mfma_f32_16x16x32_bf16 v[136:139], a[168:171], v[112:115], v[136:139]
  ds_read_b128 a[136:139], v2 offset:16384
  v_cvt_pk_bf16_f32 v99, v50, v51
  v_mfma_f32_16x16x32_bf16 v[168:171], a[168:171], v[116:119], v[168:171]
  v_exp_f32 v36, v36
  v_fma_f32 v37, v37, s20, v21
  v_mfma_f32_16x16x32_bf16 v[140:143], a[172:175], v[112:115], v[140:143]
  ds_read_b128 a[140:143], v3 offset:16384
  v_fma_f32 v38, v38, s20, v21
  v_mfma_f32_16x16x32_bf16 v[172:175], a[172:175], v[116:119], v[172:175]
  v_exp_f32 v37, v37
  v_mfma_f32_16x16x32_bf16 v[144:147], a[176:179], v[112:115], v[144:147]
  ds_read_b128 a[144:147], v0 offset:20480
  v_cvt_pk_bf16_f32 v100, v36, v37
  v_mfma_f32_16x16x32_bf16 v[176:179], a[176:179], v[116:119], v[176:179]
  v_exp_f32 v38, v38
  v_fma_f32 v39, v39, s20, v21
  v_mfma_f32_16x16x32_bf16 v[148:151], a[180:183], v[112:115], v[148:151]
  ds_read_b128 a[148:151], v1 offset:20480
  v_fma_f32 v52, v52, s20, v21
  v_mfma_f32_16x16x32_bf16 v[180:183], a[180:183], v[116:119], v[180:183]
  v_exp_f32 v39, v39
  v_mfma_f32_16x16x32_bf16 v[152:155], a[184:187], v[112:115], v[152:155]
  ds_read_b128 a[152:155], v2 offset:20480
  v_cvt_pk_bf16_f32 v101, v38, v39
  v_fma_f32 v53, v53, s20, v21
  v_mfma_f32_16x16x32_bf16 v[184:187], a[184:187], v[116:119], v[184:187]
  v_fma_f32 v54, v54, s20, v21
  s_waitcnt lgkmcnt(3)
  v_mfma_f32_16x16x32_bf16 v[156:159], a[188:191], v[112:115], v[156:159]
  ds_read_b128 a[156:159], v3 offset:20480
  v_fma_f32 v55, v55, s20, v21
  v_mfma_f32_16x16x32_bf16 v[188:191], a[188:191], v[116:119], v[188:191]
  v_fma_f32 v40, v40, s20, v22
  s_add_u32 m0, s90, 0x3000
  v_mfma_f32_16x16x32_bf16 v[192:195], a[160:163], v[120:123], v[192:195]
  buffer_load_dwordx4 v16, s[4:7], s89 offen offset:0 nt lds
  v_fma_f32 v41, v41, s20, v22
  v_mfma_f32_16x16x32_bf16 v[224:227], a[160:163], v[124:127], v[224:227]
  v_exp_f32 v52, v52
  v_mfma_f32_16x16x32_bf16 v[196:199], a[164:167], v[120:123], v[196:199]
  v_exp_f32 v53, v53
  v_mfma_f32_16x16x32_bf16 v[228:231], a[164:167], v[124:127], v[228:231]
  v_exp_f32 v54, v54
  v_cvt_pk_bf16_f32 v102, v52, v53
  v_mfma_f32_16x16x32_bf16 v[200:203], a[168:171], v[120:123], v[200:203]
  buffer_load_dwordx4 v17, s[4:7], s89 offen offset:1024 nt lds
  v_mfma_f32_16x16x32_bf16 v[232:235], a[168:171], v[124:127], v[232:235]
  v_exp_f32 v55, v55
  v_mfma_f32_16x16x32_bf16 v[204:207], a[172:175], v[120:123], v[204:207]
  v_exp_f32 v40, v40
  v_mfma_f32_16x16x32_bf16 v[236:239], a[172:175], v[124:127], v[236:239]
  v_cvt_pk_bf16_f32 v103, v54, v55
  v_exp_f32 v41, v41
  v_mfma_f32_16x16x32_bf16 v[208:211], a[176:179], v[120:123], v[208:211]
  v_fma_f32 v42, v42, s20, v22
  v_cvt_pk_bf16_f32 v104, v40, v41
  v_mfma_f32_16x16x32_bf16 v[240:243], a[176:179], v[124:127], v[240:243]
  v_exp_f32 v42, v42
  v_mfma_f32_16x16x32_bf16 v[212:215], a[180:183], v[120:123], v[212:215]
  v_fma_f32 v43, v43, s20, v22
  v_fma_f32 v56, v56, s20, v22
  v_fma_f32 v57, v57, s20, v22
  v_mfma_f32_16x16x32_bf16 v[244:247], a[180:183], v[124:127], v[244:247]
  v_exp_f32 v43, v43
  v_mfma_f32_16x16x32_bf16 v[216:219], a[184:187], v[120:123], v[216:219]
  v_exp_f32 v56, v56
  v_mfma_f32_16x16x32_bf16 v[248:251], a[184:187], v[124:127], v[248:251]
  v_exp_f32 v57, v57
  v_mfma_f32_16x16x32_bf16 v[220:223], a[188:191], v[120:123], v[220:223]
  v_cvt_pk_bf16_f32 v105, v42, v43
  v_cvt_pk_bf16_f32 v106, v56, v57
  v_fma_f32 v58, v58, s20, v22
  v_mfma_f32_16x16x32_bf16 v[252:255], a[188:191], v[124:127], v[252:255]
  s_waitcnt vmcnt(20) lgkmcnt(0)
  s_barrier
  v_mfma_f32_16x16x32_bf16 v[32:35], a[128:131], a[0:3], 0
  ds_read_b64_tr_b16 a[160:161], v4 offset:24576
  v_fma_f32 v59, v59, s20, v22
  v_mfma_f32_16x16x32_bf16 v[32:35], a[132:135], a[4:7], v[32:35]
  v_exp_f32 v58, v58
  v_mfma_f32_16x16x32_bf16 v[32:35], a[136:139], a[8:11], v[32:35]
  ds_read_b64_tr_b16 a[162:163], v4 offset:28672
  v_fma_f32 v44, v44, s20, v23
  v_mfma_f32_16x16x32_bf16 v[32:35], a[140:143], a[12:15], v[32:35]
  s_add_u32 s16, s16, 0x2000
  s_and_b32 s16, s16, 0x1ffff
  v_mfma_f32_16x16x32_bf16 v[48:51], a[144:147], a[0:3], 0
  ds_read_b64_tr_b16 a[164:165], v5 offset:24576
  v_exp_f32 v59, v59
  v_mfma_f32_16x16x32_bf16 v[48:51], a[148:151], a[4:7], v[48:51]
  v_fma_f32 v45, v45, s20, v23
  s_add_u32 m0, s19, 0x2000
  v_mfma_f32_16x16x32_bf16 v[48:51], a[152:155], a[8:11], v[48:51]
  ds_read_b64_tr_b16 a[166:167], v5 offset:28672
  v_cvt_pk_bf16_f32 v107, v58, v59
  v_mfma_f32_16x16x32_bf16 v[48:51], a[156:159], a[12:15], v[48:51]
  buffer_load_dwordx4 v12, s[8:11], s16 offen offset:0 nt lds
  v_mfma_f32_16x16x32_bf16 v[36:39], a[128:131], a[16:19], 0
  ds_read_b64_tr_b16 a[168:169], v6 offset:24576
  v_fma_f32 v46, v46, s20, v23
  v_mfma_f32_16x16x32_bf16 v[36:39], a[132:135], a[20:23], v[36:39]
  v_exp_f32 v44, v44
  v_mfma_f32_16x16x32_bf16 v[36:39], a[136:139], a[24:27], v[36:39]
  ds_read_b64_tr_b16 a[170:171], v6 offset:28672
  v_fma_f32 v47, v47, s20, v23
  v_mfma_f32_16x16x32_bf16 v[36:39], a[140:143], a[28:31], v[36:39]
  buffer_load_dwordx4 v13, s[8:11], s16 offen offset:1024 nt lds
  v_mfma_f32_16x16x32_bf16 v[52:55], a[144:147], a[16:19], 0
  ds_read_b64_tr_b16 a[172:173], v7 offset:24576
  v_exp_f32 v45, v45
  v_mfma_f32_16x16x32_bf16 v[52:55], a[148:151], a[20:23], v[52:55]
  v_exp_f32 v46, v46
  v_mfma_f32_16x16x32_bf16 v[52:55], a[152:155], a[24:27], v[52:55]
  ds_read_b64_tr_b16 a[174:175], v7 offset:28672
  v_cvt_pk_bf16_f32 v108, v44, v45
  v_mfma_f32_16x16x32_bf16 v[52:55], a[156:159], a[28:31], v[52:55]
  buffer_load_dwordx4 v14, s[8:11], s16 offen offset:2048 nt lds
  v_mfma_f32_16x16x32_bf16 v[40:43], a[128:131], a[32:35], 0
  ds_read_b64_tr_b16 a[176:177], v8 offset:24576
  v_exp_f32 v47, v47
  v_mfma_f32_16x16x32_bf16 v[40:43], a[132:135], a[36:39], v[40:43]
  v_fma_f32 v60, v60, s20, v23
  v_cvt_pk_bf16_f32 v109, v46, v47
  v_mfma_f32_16x16x32_bf16 v[40:43], a[136:139], a[40:43], v[40:43]
  ds_read_b64_tr_b16 a[178:179], v8 offset:28672
  v_exp_f32 v60, v60
  v_mfma_f32_16x16x32_bf16 v[40:43], a[140:143], a[44:47], v[40:43]
  buffer_load_dwordx4 v15, s[8:11], s16 offen offset:3072 nt lds
  v_mfma_f32_16x16x32_bf16 v[56:59], a[144:147], a[32:35], 0
  ds_read_b64_tr_b16 a[180:181], v9 offset:24576
  v_fma_f32 v61, v61, s20, v23
  v_mfma_f32_16x16x32_bf16 v[56:59], a[148:151], a[36:39], v[56:59]
  v_exp_f32 v61, v61
  v_fma_f32 v62, v62, s20, v23
  v_mfma_f32_16x16x32_bf16 v[56:59], a[152:155], a[40:43], v[56:59]
  ds_read_b64_tr_b16 a[182:183], v9 offset:28672
  v_cvt_pk_bf16_f32 v110, v60, v61
  v_mfma_f32_16x16x32_bf16 v[56:59], a[156:159], a[44:47], v[56:59]
  v_exp_f32 v62, v62
  v_mfma_f32_16x16x32_bf16 v[44:47], a[128:131], a[48:51], 0
  ds_read_b64_tr_b16 a[184:185], v10 offset:24576
  v_fma_f32 v63, v63, s20, v23
  v_fma_f32 v64, v64, s20, v20
  v_mfma_f32_16x16x32_bf16 v[44:47], a[132:135], a[52:55], v[44:47]
  v_exp_f32 v63, v63
  v_mfma_f32_16x16x32_bf16 v[44:47], a[136:139], a[56:59], v[44:47]
  ds_read_b64_tr_b16 a[186:187], v10 offset:28672
  v_cvt_pk_bf16_f32 v111, v62, v63
  v_mfma_f32_16x16x32_bf16 v[44:47], a[140:143], a[60:63], v[44:47]
  v_exp_f32 v64, v64
  v_fma_f32 v65, v65, s20, v20
  v_mfma_f32_16x16x32_bf16 v[60:63], a[144:147], a[48:51], 0
  ds_read_b64_tr_b16 a[188:189], v11 offset:24576
  v_fma_f32 v66, v66, s20, v20
  v_mfma_f32_16x16x32_bf16 v[60:63], a[148:151], a[52:55], v[60:63]
  v_exp_f32 v65, v65
  v_mfma_f32_16x16x32_bf16 v[60:63], a[152:155], a[56:59], v[60:63]
  ds_read_b64_tr_b16 a[190:191], v11 offset:28672
  v_exp_f32 v66, v66
  v_mfma_f32_16x16x32_bf16 v[60:63], a[156:159], a[60:63], v[60:63]
  v_cvt_pk_bf16_f32 v112, v64, v65
  v_fma_f32 v67, v67, s20, v20
  v_mfma_f32_16x16x32_bf16 a[96:99], a[100:103], v[96:99], a[96:99]
  v_exp_f32 v67, v67
  v_mfma_f32_16x16x32_bf16 a[96:99], a[104:107], v[100:103], a[96:99]
  v_fma_f32 v80, v80, s20, v20
  v_cvt_pk_bf16_f32 v113, v66, v67
  v_fma_f32 v81, v81, s20, v20
  v_mfma_f32_16x16x32_bf16 a[96:99], a[108:111], v[104:107], a[96:99]
  v_exp_f32 v80, v80
  v_mfma_f32_16x16x32_bf16 a[96:99], a[112:115], v[108:111], a[96:99]
  v_fma_f32 v82, v82, s20, v20
  s_waitcnt lgkmcnt(1)
  v_mfma_f32_16x16x32_bf16 v[128:131], a[160:163], v[96:99], v[128:131]
  ds_read_b128 a[128:131], v0 offset:24576
  v_exp_f32 v81, v81
  v_mfma_f32_16x16x32_bf16 v[160:163], a[160:163], v[100:103], v[160:163]
  v_exp_f32 v82, v82
  v_mfma_f32_16x16x32_bf16 v[132:135], a[164:167], v[96:99], v[132:135]
  ds_read_b128 a[132:135], v1 offset:24576
  v_cvt_pk_bf16_f32 v114, v80, v81
  v_mfma_f32_16x16x32_bf16 v[164:167], a[164:167], v[100:103], v[164:167]
  v_fma_f32 v83, v83, s20, v20
  v_fma_f32 v68, v68, s20, v21
  v_fma_f32 v69, v69, s20, v21
  v_mfma_f32_16x16x32_bf16 v[136:139], a[168:171], v[96:99], v[136:139]
  ds_read_b128 a[136:139], v2 offset:24576
  v_fma_f32 v70, v70, s20, v21
  v_mfma_f32_16x16x32_bf16 v[168:171], a[168:171], v[100:103], v[168:171]
  v_exp_f32 v83, v83
  v_mfma_f32_16x16x32_bf16 v[140:143], a[172:175], v[96:99], v[140:143]
  ds_read_b128 a[140:143], v3 offset:24576
  v_cvt_pk_bf16_f32 v115, v82, v83
  v_fma_f32 v71, v71, s20, v21
  v_mfma_f32_16x16x32_bf16 v[172:175], a[172:175], v[100:103], v[172:175]
  v_exp_f32 v68, v68
  v_mfma_f32_16x16x32_bf16 v[144:147], a[176:179], v[96:99], v[144:147]
  ds_read_b128 a[144:147], v0 offset:28672
  v_fma_f32 v84, v84, s20, v21
  v_mfma_f32_16x16x32_bf16 v[176:179], a[176:179], v[100:103], v[176:179]
  v_exp_f32 v69, v69
  v_fma_f32 v85, v85, s20, v21
  v_mfma_f32_16x16x32_bf16 v[148:151], a[180:183], v[96:99], v[148:151]
  ds_read_b128 a[148:151], v1 offset:28672
  v_cvt_pk_bf16_f32 v116, v68, v69
  v_mfma_f32_16x16x32_bf16 v[180:183], a[180:183], v[100:103], v[180:183]
  v_exp_f32 v70, v70
  v_mfma_f32_16x16x32_bf16 v[152:155], a[184:187], v[96:99], v[152:155]
  ds_read_b128 a[152:155], v2 offset:28672
  v_exp_f32 v71, v71
  v_mfma_f32_16x16x32_bf16 v[184:187], a[184:187], v[100:103], v[184:187]
  v_fma_f32 v86, v86, s20, v21
  s_waitcnt lgkmcnt(3)
  v_mfma_f32_16x16x32_bf16 v[156:159], a[188:191], v[96:99], v[156:159]
  ds_read_b128 a[156:159], v3 offset:28672
  v_cvt_pk_bf16_f32 v117, v70, v71
  v_fma_f32 v87, v87, s20, v21
  v_mfma_f32_16x16x32_bf16 v[188:191], a[188:191], v[100:103], v[188:191]
  v_fma_f32 v72, v72, s20, v22
  s_add_u32 m0, s90, 0x3000
  v_mfma_f32_16x16x32_bf16 v[192:195], a[160:163], v[104:107], v[192:195]
  buffer_load_dwordx4 v18, s[4:7], s89 offen offset:2048 nt lds
  v_mfma_f32_16x16x32_bf16 v[224:227], a[160:163], v[108:111], v[224:227]
  v_exp_f32 v84, v84
  v_fma_f32 v73, v73, s20, v22
  v_mfma_f32_16x16x32_bf16 v[196:199], a[164:167], v[104:107], v[196:199]
  v_exp_f32 v85, v85
  v_mfma_f32_16x16x32_bf16 v[228:231], a[164:167], v[108:111], v[228:231]
  v_exp_f32 v86, v86
  v_mfma_f32_16x16x32_bf16 v[200:203], a[168:171], v[104:107], v[200:203]
  buffer_load_dwordx4 v19, s[4:7], s89 offen offset:3072 nt lds
  v_cvt_pk_bf16_f32 v118, v84, v85
  v_mfma_f32_16x16x32_bf16 v[232:235], a[168:171], v[108:111], v[232:235]
  v_exp_f32 v87, v87
  v_mfma_f32_16x16x32_bf16 v[204:207], a[172:175], v[104:107], v[204:207]
  v_exp_f32 v72, v72
  v_mfma_f32_16x16x32_bf16 v[236:239], a[172:175], v[108:111], v[236:239]
  v_cvt_pk_bf16_f32 v119, v86, v87
  v_exp_f32 v73, v73
  v_mfma_f32_16x16x32_bf16 v[208:211], a[176:179], v[104:107], v[208:211]
  v_fma_f32 v74, v74, s20, v22
  v_cvt_pk_bf16_f32 v120, v72, v73
  v_mfma_f32_16x16x32_bf16 v[240:243], a[176:179], v[108:111], v[240:243]
  v_exp_f32 v74, v74
  v_mfma_f32_16x16x32_bf16 v[212:215], a[180:183], v[104:107], v[212:215]
  v_fma_f32 v75, v75, s20, v22
  v_fma_f32 v88, v88, s20, v22
  v_fma_f32 v89, v89, s20, v22
  v_mfma_f32_16x16x32_bf16 v[244:247], a[180:183], v[108:111], v[244:247]
  v_exp_f32 v75, v75
  v_mfma_f32_16x16x32_bf16 v[216:219], a[184:187], v[104:107], v[216:219]
  v_exp_f32 v88, v88
  v_mfma_f32_16x16x32_bf16 v[248:251], a[184:187], v[108:111], v[248:251]
  v_cvt_pk_bf16_f32 v121, v74, v75
  v_exp_f32 v89, v89
  v_mfma_f32_16x16x32_bf16 v[220:223], a[188:191], v[104:107], v[220:223]
  v_fma_f32 v90, v90, s20, v22
  v_cvt_pk_bf16_f32 v122, v88, v89
  v_mfma_f32_16x16x32_bf16 v[252:255], a[188:191], v[108:111], v[252:255]
  s_waitcnt vmcnt(20) lgkmcnt(0)
  s_barrier
  v_mfma_f32_16x16x32_bf16 v[64:67], a[128:131], a[0:3], 0
  ds_read_b64_tr_b16 a[160:161], v4 offset:32768
  v_exp_f32 v90, v90
  v_mfma_f32_16x16x32_bf16 v[64:67], a[132:135], a[4:7], v[64:67]
  v_fma_f32 v91, v91, s20, v22
  v_fma_f32 v76, v76, s20, v23
  v_mfma_f32_16x16x32_bf16 v[64:67], a[136:139], a[8:11], v[64:67]
  ds_read_b64_tr_b16 a[162:163], v4 offset:36864
  v_fma_f32 v77, v77, s20, v23
  v_mfma_f32_16x16x32_bf16 v[64:67], a[140:143], a[12:15], v[64:67]
  s_add_u32 s16, s16, 0x2000
  s_and_b32 s16, s16, 0x1ffff
  v_mfma_f32_16x16x32_bf16 v[80:83], a[144:147], a[0:3], 0
  ds_read_b64_tr_b16 a[164:165], v5 offset:32768
  v_fma_f32 v78, v78, s20, v23
  v_mfma_f32_16x16x32_bf16 v[80:83], a[148:151], a[4:7], v[80:83]
  v_fma_f32 v79, v79, s20, v23
  s_add_u32 m0, s19, 0x4000
  v_mfma_f32_16x16x32_bf16 v[80:83], a[152:155], a[8:11], v[80:83]
  ds_read_b64_tr_b16 a[166:167], v5 offset:36864
  v_exp_f32 v91, v91
  v_mfma_f32_16x16x32_bf16 v[80:83], a[156:159], a[12:15], v[80:83]
  buffer_load_dwordx4 v12, s[8:11], s16 offen offset:0 nt lds
  v_mfma_f32_16x16x32_bf16 v[68:71], a[128:131], a[16:19], 0
  ds_read_b64_tr_b16 a[168:169], v6 offset:32768
  v_cvt_pk_bf16_f32 v123, v90, v91
  v_mfma_f32_16x16x32_bf16 v[68:71], a[132:135], a[20:23], v[68:71]
  s_add_u32 s4, s4, 0xf80000
  s_addc_u32 s5, s5, 0
  v_mfma_f32_16x16x32_bf16 v[68:71], a[136:139], a[24:27], v[68:71]
  ds_read_b64_tr_b16 a[170:171], v6 offset:36864
  v_exp_f32 v76, v76
  v_mfma_f32_16x16x32_bf16 v[68:71], a[140:143], a[28:31], v[68:71]
  buffer_load_dwordx4 v13, s[8:11], s16 offen offset:1024 nt lds
  v_mfma_f32_16x16x32_bf16 v[84:87], a[144:147], a[16:19], 0
  ds_read_b64_tr_b16 a[172:173], v7 offset:32768
  v_fma_f32 v92, v92, s20, v23
  v_mfma_f32_16x16x32_bf16 v[84:87], a[148:151], a[20:23], v[84:87]
  v_exp_f32 v77, v77
  v_fma_f32 v93, v93, s20, v23
  v_mfma_f32_16x16x32_bf16 v[84:87], a[152:155], a[24:27], v[84:87]
  ds_read_b64_tr_b16 a[174:175], v7 offset:36864
  v_cvt_pk_bf16_f32 v124, v76, v77
  v_mfma_f32_16x16x32_bf16 v[84:87], a[156:159], a[28:31], v[84:87]
  buffer_load_dwordx4 v14, s[8:11], s16 offen offset:2048 nt lds
  v_mfma_f32_16x16x32_bf16 v[72:75], a[128:131], a[32:35], 0
  ds_read_b64_tr_b16 a[176:177], v8 offset:32768
  v_exp_f32 v78, v78
  v_mfma_f32_16x16x32_bf16 v[72:75], a[132:135], a[36:39], v[72:75]
  v_exp_f32 v79, v79
  v_mfma_f32_16x16x32_bf16 v[72:75], a[136:139], a[40:43], v[72:75]
  ds_read_b64_tr_b16 a[178:179], v8 offset:36864
  v_cvt_pk_bf16_f32 v125, v78, v79
  v_fma_f32 v94, v94, s20, v23
  v_mfma_f32_16x16x32_bf16 v[72:75], a[140:143], a[44:47], v[72:75]
  buffer_load_dwordx4 v15, s[8:11], s16 offen offset:3072 nt lds
  v_mfma_f32_16x16x32_bf16 v[88:91], a[144:147], a[32:35], 0
  ds_read_b64_tr_b16 a[180:181], v9 offset:32768
  v_fma_f32 v95, v95, s20, v23
  v_mfma_f32_16x16x32_bf16 v[88:91], a[148:151], a[36:39], v[88:91]
  v_exp_f32 v92, v92
  v_fma_f32 v32, v32, s20, v20
  v_mfma_f32_16x16x32_bf16 v[88:91], a[152:155], a[40:43], v[88:91]
  ds_read_b64_tr_b16 a[182:183], v9 offset:36864
  v_fma_f32 v33, v33, s20, v20
  v_mfma_f32_16x16x32_bf16 v[88:91], a[156:159], a[44:47], v[88:91]
  v_exp_f32 v93, v93
  v_fma_f32 v34, v34, s20, v20
  v_mfma_f32_16x16x32_bf16 v[76:79], a[128:131], a[48:51], 0
  ds_read_b64_tr_b16 a[184:185], v10 offset:32768
  v_cvt_pk_bf16_f32 v126, v92, v93
  v_mfma_f32_16x16x32_bf16 v[76:79], a[132:135], a[52:55], v[76:79]
  v_exp_f32 v94, v94
  v_fma_f32 v35, v35, s20, v20
  v_mfma_f32_16x16x32_bf16 v[76:79], a[136:139], a[56:59], v[76:79]
  ds_read_b64_tr_b16 a[186:187], v10 offset:36864
  v_fma_f32 v48, v48, s20, v20
  v_mfma_f32_16x16x32_bf16 v[76:79], a[140:143], a[60:63], v[76:79]
  v_exp_f32 v95, v95
  v_fma_f32 v49, v49, s20, v20
  v_fma_f32 v50, v50, s20, v20
  v_cvt_pk_bf16_f32 v127, v94, v95
  v_mfma_f32_16x16x32_bf16 v[92:95], a[144:147], a[48:51], 0
  ds_read_b64_tr_b16 a[188:189], v11 offset:32768
  v_exp_f32 v32, v32
  v_mfma_f32_16x16x32_bf16 v[92:95], a[148:151], a[52:55], v[92:95]
  v_exp_f32 v33, v33
  v_mfma_f32_16x16x32_bf16 v[92:95], a[152:155], a[56:59], v[92:95]
  ds_read_b64_tr_b16 a[190:191], v11 offset:36864
  v_cvt_pk_bf16_f32 v96, v32, v33
  v_mfma_f32_16x16x32_bf16 v[92:95], a[156:159], a[60:63], v[92:95]
  v_exp_f32 v34, v34
  v_fma_f32 v51, v51, s20, v20
  v_mfma_f32_16x16x32_bf16 a[96:99], a[100:103], v[112:115], a[96:99]
  v_exp_f32 v35, v35
  v_mfma_f32_16x16x32_bf16 a[96:99], a[104:107], v[116:119], a[96:99]
  v_exp_f32 v48, v48
  v_cvt_pk_bf16_f32 v97, v34, v35
  v_mfma_f32_16x16x32_bf16 a[96:99], a[108:111], v[120:123], a[96:99]
  v_exp_f32 v49, v49
  v_mfma_f32_16x16x32_bf16 a[96:99], a[112:115], v[124:127], a[96:99]
  v_fma_f32 v36, v36, s20, v21
  s_waitcnt lgkmcnt(1)
  v_mfma_f32_16x16x32_bf16 v[128:131], a[160:163], v[112:115], v[128:131]
  ds_read_b128 a[128:131], v0 offset:32768
  v_exp_f32 v50, v50
  v_mfma_f32_16x16x32_bf16 v[160:163], a[160:163], v[116:119], v[160:163]
  v_exp_f32 v51, v51
  v_mfma_f32_16x16x32_bf16 v[132:135], a[164:167], v[112:115], v[132:135]
  ds_read_b128 a[132:135], v1 offset:32768
  v_cvt_pk_bf16_f32 v98, v48, v49
  v_cvt_pk_bf16_f32 v99, v50, v51
  v_mfma_f32_16x16x32_bf16 v[164:167], a[164:167], v[116:119], v[164:167]
  v_exp_f32 v36, v36
  v_mfma_f32_16x16x32_bf16 v[136:139], a[168:171], v[112:115], v[136:139]
  ds_read_b128 a[136:139], v2 offset:32768
  v_fma_f32 v37, v37, s20, v21
  v_mfma_f32_16x16x32_bf16 v[168:171], a[168:171], v[116:119], v[168:171]
  v_exp_f32 v37, v37
  v_fma_f32 v38, v38, s20, v21
  v_mfma_f32_16x16x32_bf16 v[140:143], a[172:175], v[112:115], v[140:143]
  ds_read_b128 a[140:143], v3 offset:32768
  v_cvt_pk_bf16_f32 v100, v36, v37
  v_mfma_f32_16x16x32_bf16 v[172:175], a[172:175], v[116:119], v[172:175]
  v_exp_f32 v38, v38
  v_fma_f32 v39, v39, s20, v21
  v_mfma_f32_16x16x32_bf16 v[144:147], a[176:179], v[112:115], v[144:147]
  ds_read_b128 a[144:147], v0 offset:36864
  v_fma_f32 v52, v52, s20, v21
  v_mfma_f32_16x16x32_bf16 v[176:179], a[176:179], v[116:119], v[176:179]
  v_exp_f32 v39, v39
  v_fma_f32 v53, v53, s20, v21
  v_mfma_f32_16x16x32_bf16 v[148:151], a[180:183], v[112:115], v[148:151]
  ds_read_b128 a[148:151], v1 offset:36864
  v_cvt_pk_bf16_f32 v101, v38, v39
  v_mfma_f32_16x16x32_bf16 v[180:183], a[180:183], v[116:119], v[180:183]
  v_exp_f32 v52, v52
  v_mfma_f32_16x16x32_bf16 v[152:155], a[184:187], v[112:115], v[152:155]
  ds_read_b128 a[152:155], v2 offset:36864
  v_exp_f32 v53, v53
  v_mfma_f32_16x16x32_bf16 v[184:187], a[184:187], v[116:119], v[184:187]
  v_fma_f32 v54, v54, s20, v21
  s_waitcnt lgkmcnt(3)
  v_mfma_f32_16x16x32_bf16 v[156:159], a[188:191], v[112:115], v[156:159]
  ds_read_b128 a[156:159], v3 offset:36864
  v_exp_f32 v54, v54
  v_mfma_f32_16x16x32_bf16 v[188:191], a[188:191], v[116:119], v[188:191]
  v_cvt_pk_bf16_f32 v102, v52, v53
  v_fma_f32 v55, v55, s20, v21
  v_mfma_f32_16x16x32_bf16 v[192:195], a[160:163], v[120:123], v[192:195]
  v_exp_f32 v55, v55
  v_mfma_f32_16x16x32_bf16 v[224:227], a[160:163], v[124:127], v[224:227]
  v_fma_f32 v40, v40, s20, v22
  v_cvt_pk_bf16_f32 v103, v54, v55
  v_fma_f32 v41, v41, s20, v22
  v_mfma_f32_16x16x32_bf16 v[196:199], a[164:167], v[120:123], v[196:199]
  buffer_store_dwordx4 a[208:211], v16, s[12:15], s87 offen offset:0 nt
  v_mfma_f32_16x16x32_bf16 v[228:231], a[164:167], v[124:127], v[228:231]
  v_exp_f32 v40, v40
  v_fma_f32 v42, v42, s20, v22
  v_mfma_f32_16x16x32_bf16 v[200:203], a[168:171], v[120:123], v[200:203]
  v_exp_f32 v41, v41
  v_mfma_f32_16x16x32_bf16 v[232:235], a[168:171], v[124:127], v[232:235]
  v_exp_f32 v42, v42
  v_mfma_f32_16x16x32_bf16 v[204:207], a[172:175], v[120:123], v[204:207]
  v_cvt_pk_bf16_f32 v104, v40, v41
  v_fma_f32 v43, v43, s20, v22
  v_mfma_f32_16x16x32_bf16 v[236:239], a[172:175], v[124:127], v[236:239]
  v_exp_f32 v43, v43
  v_fma_f32 v56, v56, s20, v22
  v_mfma_f32_16x16x32_bf16 v[208:211], a[176:179], v[120:123], v[208:211]
  v_exp_f32 v56, v56
  v_mfma_f32_16x16x32_bf16 v[240:243], a[176:179], v[124:127], v[240:243]
  v_cvt_pk_bf16_f32 v105, v42, v43
  v_fma_f32 v57, v57, s20, v22
  v_mfma_f32_16x16x32_bf16 v[212:215], a[180:183], v[120:123], v[212:215]
  buffer_store_dwordx4 a[204:207], v19, s[12:15], 0 offen offset:3072 nt
  v_mfma_f32_16x16x32_bf16 v[244:247], a[180:183], v[124:127], v[244:247]
  v_exp_f32 v57, v57
  v_mfma_f32_16x16x32_bf16 v[216:219], a[184:187], v[120:123], v[216:219]
  v_fma_f32 v58, v58, s20, v22
  v_cvt_pk_bf16_f32 v106, v56, v57
  v_mfma_f32_16x16x32_bf16 v[248:251], a[184:187], v[124:127], v[248:251]
  v_exp_f32 v58, v58
  v_mfma_f32_16x16x32_bf16 v[220:223], a[188:191], v[120:123], v[220:223]
  v_fma_f32 v59, v59, s20, v22
  v_fma_f32 v44, v44, s20, v23
  v_fma_f32 v45, v45, s20, v23
  v_mfma_f32_16x16x32_bf16 v[252:255], a[188:191], v[124:127], v[252:255]
  s_waitcnt vmcnt(20) lgkmcnt(0)
  s_barrier
  v_mfma_f32_16x16x32_bf16 v[32:35], a[128:131], a[0:3], 0
  ds_read_b64_tr_b16 a[160:161], v4 offset:40960
  v_fma_f32 v46, v46, s20, v23
  v_mfma_f32_16x16x32_bf16 v[32:35], a[132:135], a[4:7], v[32:35]
  s_mov_b32 s10, s23
  s_add_u32 s8, s8, s18
  s_addc_u32 s9, s9, 0
  v_mfma_f32_16x16x32_bf16 v[32:35], a[136:139], a[8:11], v[32:35]
  ds_read_b64_tr_b16 a[162:163], v4 offset:45056
  v_fma_f32 v47, v47, s20, v23
  v_mfma_f32_16x16x32_bf16 v[32:35], a[140:143], a[12:15], v[32:35]
  s_add_u32 s16, s16, 0x2000
  s_and_b32 s16, s16, 0x1ffff
  v_mfma_f32_16x16x32_bf16 v[48:51], a[144:147], a[0:3], 0
  ds_read_b64_tr_b16 a[164:165], v5 offset:40960
  v_fma_f32 v60, v60, s20, v23
  v_mfma_f32_16x16x32_bf16 v[48:51], a[148:151], a[4:7], v[48:51]
  v_fma_f32 v61, v61, s20, v23
  s_add_u32 m0, s19, 0x6000
  v_mfma_f32_16x16x32_bf16 v[48:51], a[152:155], a[8:11], v[48:51]
  ds_read_b64_tr_b16 a[166:167], v5 offset:45056
  v_fma_f32 v62, v62, s20, v23
  v_mfma_f32_16x16x32_bf16 v[48:51], a[156:159], a[12:15], v[48:51]
  buffer_load_dwordx4 v12, s[8:11], s16 offen offset:0 nt lds
  v_fma_f32 v63, v63, s20, v23
  v_mfma_f32_16x16x32_bf16 v[36:39], a[128:131], a[16:19], 0
  ds_read_b64_tr_b16 a[168:169], v6 offset:40960
  v_fma_f32 v64, v64, s20, v20
  v_mfma_f32_16x16x32_bf16 v[36:39], a[132:135], a[20:23], v[36:39]
  v_exp_f32 v59, v59
  v_mfma_f32_16x16x32_bf16 v[36:39], a[136:139], a[24:27], v[36:39]
  ds_read_b64_tr_b16 a[170:171], v6 offset:45056
  v_cvt_pk_bf16_f32 v107, v58, v59
  v_mfma_f32_16x16x32_bf16 v[36:39], a[140:143], a[28:31], v[36:39]
  buffer_load_dwordx4 v13, s[8:11], s16 offen offset:1024 nt lds
  v_fma_f32 v65, v65, s20, v20
  v_mfma_f32_16x16x32_bf16 v[52:55], a[144:147], a[16:19], 0
  ds_read_b64_tr_b16 a[172:173], v7 offset:40960
  v_fma_f32 v66, v66, s20, v20
  v_mfma_f32_16x16x32_bf16 v[52:55], a[148:151], a[20:23], v[52:55]
  v_exp_f32 v44, v44
  v_mfma_f32_16x16x32_bf16 v[52:55], a[152:155], a[24:27], v[52:55]
  ds_read_b64_tr_b16 a[174:175], v7 offset:45056
  v_exp_f32 v45, v45
  v_mfma_f32_16x16x32_bf16 v[52:55], a[156:159], a[28:31], v[52:55]
  buffer_load_dwordx4 v14, s[8:11], s16 offen offset:2048 nt lds
  v_mfma_f32_16x16x32_bf16 v[40:43], a[128:131], a[32:35], 0
  ds_read_b64_tr_b16 a[176:177], v8 offset:40960
  v_cvt_pk_bf16_f32 v108, v44, v45
  v_mfma_f32_16x16x32_bf16 v[40:43], a[132:135], a[36:39], v[40:43]
  v_exp_f32 v46, v46
  v_fma_f32 v67, v67, s20, v20
  v_mfma_f32_16x16x32_bf16 v[40:43], a[136:139], a[40:43], v[40:43]
  ds_read_b64_tr_b16 a[178:179], v8 offset:45056
  v_fma_f32 v80, v80, s20, v20
  v_mfma_f32_16x16x32_bf16 v[40:43], a[140:143], a[44:47], v[40:43]
  buffer_load_dwordx4 v15, s[8:11], s16 offen offset:3072 nt lds
  v_fma_f32 v81, v81, s20, v20
  v_mfma_f32_16x16x32_bf16 v[56:59], a[144:147], a[32:35], 0
  ds_read_b64_tr_b16 a[180:181], v9 offset:40960
  v_fma_f32 v82, v82, s20, v20
  v_mfma_f32_16x16x32_bf16 v[56:59], a[148:151], a[36:39], v[56:59]
  v_exp_f32 v47, v47
  v_fma_f32 v83, v83, s20, v20
  v_mfma_f32_16x16x32_bf16 v[56:59], a[152:155], a[40:43], v[56:59]
  ds_read_b64_tr_b16 a[182:183], v9 offset:45056
  v_cvt_pk_bf16_f32 v109, v46, v47
  v_mfma_f32_16x16x32_bf16 v[56:59], a[156:159], a[44:47], v[56:59]
  v_exp_f32 v60, v60
  v_fma_f32 v68, v68, s20, v21
  v_mfma_f32_16x16x32_bf16 v[44:47], a[128:131], a[48:51], 0
  ds_read_b64_tr_b16 a[184:185], v10 offset:40960
  v_fma_f32 v69, v69, s20, v21
  v_mfma_f32_16x16x32_bf16 v[44:47], a[132:135], a[52:55], v[44:47]
  v_exp_f32 v61, v61
  v_fma_f32 v70, v70, s20, v21
  v_mfma_f32_16x16x32_bf16 v[44:47], a[136:139], a[56:59], v[44:47]
  ds_read_b64_tr_b16 a[186:187], v10 offset:45056
  v_exp_f32 v62, v62
  v_cvt_pk_bf16_f32 v110, v60, v61
  v_mfma_f32_16x16x32_bf16 v[44:47], a[140:143], a[60:63], v[44:47]
  v_exp_f32 v63, v63
  v_fma_f32 v71, v71, s20, v21
  v_fma_f32 v84, v84, s20, v21
  v_cvt_pk_bf16_f32 v111, v62, v63
  v_mfma_f32_16x16x32_bf16 v[60:63], a[144:147], a[48:51], 0
  ds_read_b64_tr_b16 a[188:189], v11 offset:40960
  v_fma_f32 v85, v85, s20, v21
  v_mfma_f32_16x16x32_bf16 v[60:63], a[148:151], a[52:55], v[60:63]
  v_exp_f32 v64, v64
  v_mfma_f32_16x16x32_bf16 v[60:63], a[152:155], a[56:59], v[60:63]
  ds_read_b64_tr_b16 a[190:191], v11 offset:45056
  v_exp_f32 v65, v65
  v_mfma_f32_16x16x32_bf16 v[60:63], a[156:159], a[60:63], v[60:63]
  v_exp_f32 v66, v66
  v_mfma_f32_16x16x32_bf16 a[96:99], a[100:103], v[96:99], a[96:99]
  v_exp_f32 v67, v67
  v_mfma_f32_16x16x32_bf16 a[96:99], a[104:107], v[100:103], a[96:99]
  v_cvt_pk_bf16_f32 v112, v64, v65
  v_cvt_pk_bf16_f32 v113, v66, v67
  v_fma_f32 v86, v86, s20, v21
  v_mfma_f32_16x16x32_bf16 a[96:99], a[108:111], v[104:107], a[96:99]
  v_exp_f32 v80, v80
  v_mfma_f32_16x16x32_bf16 a[96:99], a[112:115], v[108:111], a[96:99]
  v_exp_f32 v81, v81
  s_waitcnt lgkmcnt(1)
  v_mfma_f32_16x16x32_bf16 v[128:131], a[160:163], v[96:99], v[128:131]
  ds_read_b128 a[128:131], v0 offset:40960
  v_cvt_pk_bf16_f32 v114, v80, v81
  v_mfma_f32_16x16x32_bf16 v[160:163], a[160:163], v[100:103], v[160:163]
  v_exp_f32 v82, v82
  v_mfma_f32_16x16x32_bf16 v[132:135], a[164:167], v[96:99], v[132:135]
  ds_read_b128 a[132:135], v1 offset:40960
  v_exp_f32 v83, v83
  v_mfma_f32_16x16x32_bf16 v[164:167], a[164:167], v[100:103], v[164:167]
  v_exp_f32 v68, v68
  v_mfma_f32_16x16x32_bf16 v[136:139], a[168:171], v[96:99], v[136:139]
  ds_read_b128 a[136:139], v2 offset:40960
  v_cvt_pk_bf16_f32 v115, v82, v83
  v_mfma_f32_16x16x32_bf16 v[168:171], a[168:171], v[100:103], v[168:171]
  v_exp_f32 v69, v69
  v_fma_f32 v87, v87, s20, v21
  v_mfma_f32_16x16x32_bf16 v[140:143], a[172:175], v[96:99], v[140:143]
  ds_read_b128 a[140:143], v3 offset:40960
  v_cvt_pk_bf16_f32 v116, v68, v69
  v_mfma_f32_16x16x32_bf16 v[172:175], a[172:175], v[100:103], v[172:175]
  v_exp_f32 v70, v70
  v_fma_f32 v72, v72, s20, v22
  v_mfma_f32_16x16x32_bf16 v[144:147], a[176:179], v[96:99], v[144:147]
  ds_read_b128 a[144:147], v0 offset:45056
  v_fma_f32 v73, v73, s20, v22
  v_mfma_f32_16x16x32_bf16 v[176:179], a[176:179], v[100:103], v[176:179]
  v_exp_f32 v71, v71
  v_mfma_f32_16x16x32_bf16 v[148:151], a[180:183], v[96:99], v[148:151]
  ds_read_b128 a[148:151], v1 offset:45056
  v_cvt_pk_bf16_f32 v117, v70, v71
  v_fma_f32 v74, v74, s20, v22
  v_mfma_f32_16x16x32_bf16 v[180:183], a[180:183], v[100:103], v[180:183]
  v_exp_f32 v84, v84
  v_mfma_f32_16x16x32_bf16 v[152:155], a[184:187], v[96:99], v[152:155]
  ds_read_b128 a[152:155], v2 offset:45056
  v_fma_f32 v75, v75, s20, v22
  v_mfma_f32_16x16x32_bf16 v[184:187], a[184:187], v[100:103], v[184:187]
  v_exp_f32 v85, v85
  s_waitcnt lgkmcnt(3)
  v_mfma_f32_16x16x32_bf16 v[156:159], a[188:191], v[96:99], v[156:159]
  ds_read_b128 a[156:159], v3 offset:45056
  v_cvt_pk_bf16_f32 v118, v84, v85
  v_mfma_f32_16x16x32_bf16 v[188:191], a[188:191], v[100:103], v[188:191]
  v_exp_f32 v86, v86
  v_fma_f32 v88, v88, s20, v22
  v_mfma_f32_16x16x32_bf16 v[192:195], a[160:163], v[104:107], v[192:195]
  v_exp_f32 v87, v87
  v_mfma_f32_16x16x32_bf16 v[224:227], a[160:163], v[108:111], v[224:227]
  v_exp_f32 v72, v72
  v_mfma_f32_16x16x32_bf16 v[196:199], a[164:167], v[104:107], v[196:199]
  buffer_store_dwordx4 a[216:219], v18, s[12:15], s87 offen offset:2048 nt
  v_mfma_f32_16x16x32_bf16 v[228:231], a[164:167], v[108:111], v[228:231]
  v_exp_f32 v73, v73
  v_mfma_f32_16x16x32_bf16 v[200:203], a[168:171], v[104:107], v[200:203]
  v_exp_f32 v74, v74
  v_mfma_f32_16x16x32_bf16 v[232:235], a[168:171], v[108:111], v[232:235]
  v_cvt_pk_bf16_f32 v119, v86, v87
  v_exp_f32 v75, v75
  v_mfma_f32_16x16x32_bf16 v[204:207], a[172:175], v[104:107], v[204:207]
  buffer_store_dwordx4 a[220:223], v19, s[12:15], s87 offen offset:3072 nt
  v_mfma_f32_16x16x32_bf16 v[236:239], a[172:175], v[108:111], v[236:239]
  v_exp_f32 v88, v88
  v_mfma_f32_16x16x32_bf16 v[208:211], a[176:179], v[104:107], v[208:211]
  v_cvt_pk_bf16_f32 v120, v72, v73
  v_cvt_pk_bf16_f32 v121, v74, v75
  v_mfma_f32_16x16x32_bf16 v[240:243], a[176:179], v[108:111], v[240:243]
  v_fma_f32 v89, v89, s20, v22
  v_fma_f32 v90, v90, s20, v22
  v_mfma_f32_16x16x32_bf16 v[212:215], a[180:183], v[104:107], v[212:215]
  buffer_store_dwordx4 a[212:215], v17, s[12:15], s87 offen offset:1024 nt
  v_mfma_f32_16x16x32_bf16 v[244:247], a[180:183], v[108:111], v[244:247]
  v_exp_f32 v89, v89
  v_mfma_f32_16x16x32_bf16 v[216:219], a[184:187], v[104:107], v[216:219]
  v_exp_f32 v90, v90
  v_mfma_f32_16x16x32_bf16 v[248:251], a[184:187], v[108:111], v[248:251]
  v_cvt_pk_bf16_f32 v122, v88, v89
  v_fma_f32 v91, v91, s20, v22
  v_mfma_f32_16x16x32_bf16 v[220:223], a[188:191], v[104:107], v[220:223]
  v_exp_f32 v91, v91
  v_fma_f32 v76, v76, s20, v23
  v_mfma_f32_16x16x32_bf16 v[252:255], a[188:191], v[108:111], v[252:255]
  s_waitcnt vmcnt(13) lgkmcnt(0)
  s_barrier
  v_mfma_f32_16x16x32_bf16 v[64:67], a[128:131], a[0:3], 0
  ds_read_b64_tr_b16 a[160:161], v4 offset:0
  v_cvt_pk_bf16_f32 v123, v90, v91
  v_mfma_f32_16x16x32_bf16 v[64:67], a[132:135], a[4:7], v[64:67]
  v_exp_f32 v76, v76
  v_fma_f32 v77, v77, s20, v23
  v_mfma_f32_16x16x32_bf16 v[64:67], a[136:139], a[8:11], v[64:67]
  ds_read_b64_tr_b16 a[162:163], v4 offset:4096
  v_fma_f32 v78, v78, s20, v23
  v_mfma_f32_16x16x32_bf16 v[64:67], a[140:143], a[12:15], v[64:67]
  s_add_u32 s16, s16, 0x2000
  s_and_b32 s16, s16, 0x1ffff
  v_mfma_f32_16x16x32_bf16 v[80:83], a[144:147], a[0:3], 0
  ds_read_b64_tr_b16 a[164:165], v5 offset:0
  v_exp_f32 v77, v77
  v_mfma_f32_16x16x32_bf16 v[80:83], a[148:151], a[4:7], v[80:83]
  v_fma_f32 v79, v79, s20, v23
  s_add_u32 m0, s19, 0x8000
  v_mfma_f32_16x16x32_bf16 v[80:83], a[152:155], a[8:11], v[80:83]
  ds_read_b64_tr_b16 a[166:167], v5 offset:4096
  v_cvt_pk_bf16_f32 v124, v76, v77
  v_mfma_f32_16x16x32_bf16 v[80:83], a[156:159], a[12:15], v[80:83]
  buffer_load_dwordx4 v12, s[8:11], s16 offen offset:0 nt lds
  v_fma_f32 v92, v92, s20, v23
  v_mfma_f32_16x16x32_bf16 v[68:71], a[128:131], a[16:19], 0
  ds_read_b64_tr_b16 a[168:169], v6 offset:0
  v_fma_f32 v93, v93, s20, v23
  v_mfma_f32_16x16x32_bf16 v[68:71], a[132:135], a[20:23], v[68:71]
  v_exp_f32 v78, v78
  v_fma_f32 v94, v94, s20, v23
  v_mfma_f32_16x16x32_bf16 v[68:71], a[136:139], a[24:27], v[68:71]
  ds_read_b64_tr_b16 a[170:171], v6 offset:4096
  v_exp_f32 v79, v79
  v_mfma_f32_16x16x32_bf16 v[68:71], a[140:143], a[28:31], v[68:71]
  buffer_load_dwordx4 v13, s[8:11], s16 offen offset:1024 nt lds
  v_mfma_f32_16x16x32_bf16 v[84:87], a[144:147], a[16:19], 0
  ds_read_b64_tr_b16 a[172:173], v7 offset:0
  v_cvt_pk_bf16_f32 v125, v78, v79
  v_fma_f32 v95, v95, s20, v23
  v_mfma_f32_16x16x32_bf16 v[84:87], a[148:151], a[20:23], v[84:87]
  v_exp_f32 v92, v92
  v_mfma_f32_16x16x32_bf16 v[84:87], a[152:155], a[24:27], v[84:87]
  ds_read_b64_tr_b16 a[174:175], v7 offset:4096
  v_exp_f32 v93, v93
  v_mfma_f32_16x16x32_bf16 v[84:87], a[156:159], a[28:31], v[84:87]
  buffer_load_dwordx4 v14, s[8:11], s16 offen offset:2048 nt lds
  v_cvt_pk_bf16_f32 v126, v92, v93
  v_mfma_f32_16x16x32_bf16 v[72:75], a[128:131], a[32:35], 0
  ds_read_b64_tr_b16 a[176:177], v8 offset:0
  v_fma_f32 v32, v32, s20, v20
  v_mfma_f32_16x16x32_bf16 v[72:75], a[132:135], a[36:39], v[72:75]
  v_exp_f32 v94, v94
  v_fma_f32 v33, v33, s20, v20
  v_mfma_f32_16x16x32_bf16 v[72:75], a[136:139], a[40:43], v[72:75]
  ds_read_b64_tr_b16 a[178:179], v8 offset:4096
  v_exp_f32 v95, v95
  v_mfma_f32_16x16x32_bf16 v[72:75], a[140:143], a[44:47], v[72:75]
  buffer_load_dwordx4 v15, s[8:11], s16 offen offset:3072 nt lds
  v_mfma_f32_16x16x32_bf16 v[88:91], a[144:147], a[32:35], 0
  ds_read_b64_tr_b16 a[180:181], v9 offset:0
  v_cvt_pk_bf16_f32 v127, v94, v95
  v_fma_f32 v34, v34, s20, v20
  v_mfma_f32_16x16x32_bf16 v[88:91], a[148:151], a[36:39], v[88:91]
  v_exp_f32 v32, v32
  v_fma_f32 v35, v35, s20, v20
  v_mfma_f32_16x16x32_bf16 v[88:91], a[152:155], a[40:43], v[88:91]
  ds_read_b64_tr_b16 a[182:183], v9 offset:4096
  v_fma_f32 v48, v48, s20, v20
  v_mfma_f32_16x16x32_bf16 v[88:91], a[156:159], a[44:47], v[88:91]
  v_exp_f32 v33, v33
  v_fma_f32 v49, v49, s20, v20
  v_mfma_f32_16x16x32_bf16 v[76:79], a[128:131], a[48:51], 0
  ds_read_b64_tr_b16 a[184:185], v10 offset:0
  v_exp_f32 v34, v34
  v_mfma_f32_16x16x32_bf16 v[76:79], a[132:135], a[52:55], v[76:79]
  v_exp_f32 v35, v35
  v_cvt_pk_bf16_f32 v96, v32, v33
  v_mfma_f32_16x16x32_bf16 v[76:79], a[136:139], a[56:59], v[76:79]
  ds_read_b64_tr_b16 a[186:187], v10 offset:4096
  v_cvt_pk_bf16_f32 v97, v34, v35
  v_mfma_f32_16x16x32_bf16 v[76:79], a[140:143], a[60:63], v[76:79]
  v_exp_f32 v48, v48
  v_fma_f32 v50, v50, s20, v20
  v_mfma_f32_16x16x32_bf16 v[92:95], a[144:147], a[48:51], 0
  ds_read_b64_tr_b16 a[188:189], v11 offset:0
  v_exp_f32 v49, v49
  v_mfma_f32_16x16x32_bf16 v[92:95], a[148:151], a[52:55], v[92:95]
  v_exp_f32 v50, v50
  v_mfma_f32_16x16x32_bf16 v[92:95], a[152:155], a[56:59], v[92:95]
  ds_read_b64_tr_b16 a[190:191], v11 offset:4096
  v_cvt_pk_bf16_f32 v98, v48, v49
  v_fma_f32 v51, v51, s20, v20
  v_mfma_f32_16x16x32_bf16 v[92:95], a[156:159], a[60:63], v[92:95]
  v_exp_f32 v51, v51
  v_fma_f32 v36, v36, s20, v21
  v_mfma_f32_16x16x32_bf16 a[96:99], a[100:103], v[112:115], a[96:99]
  v_exp_f32 v36, v36
  v_mfma_f32_16x16x32_bf16 a[96:99], a[104:107], v[116:119], a[96:99]
  v_cvt_pk_bf16_f32 v99, v50, v51
  v_fma_f32 v37, v37, s20, v21
  v_fma_f32 v38, v38, s20, v21
  v_mfma_f32_16x16x32_bf16 a[96:99], a[108:111], v[120:123], a[96:99]
  v_exp_f32 v37, v37
  v_fma_f32 v39, v39, s20, v21
  v_mfma_f32_16x16x32_bf16 a[96:99], a[112:115], v[124:127], a[96:99]
  v_cvt_pk_bf16_f32 v100, v36, v37
  s_waitcnt lgkmcnt(1)
  v_mfma_f32_16x16x32_bf16 v[128:131], a[160:163], v[112:115], v[128:131]
  ds_read_b128 a[128:131], v0 offset:0
  v_fma_f32 v52, v52, s20, v21
  v_add_u32 v30, s90, v0
  v_mfma_f32_16x16x32_bf16 v[160:163], a[160:163], v[116:119], v[160:163]
  ds_read_b128 a[0:3], v30 offset:0
  v_exp_f32 v38, v38
  v_mfma_f32_16x16x32_bf16 v[132:135], a[164:167], v[112:115], v[132:135]
  ds_read_b128 a[132:135], v1 offset:0
  v_exp_f32 v39, v39
  v_mfma_f32_16x16x32_bf16 v[164:167], a[164:167], v[116:119], v[164:167]
  ds_read_b128 a[16:19], v30 offset:4096
  v_cvt_pk_bf16_f32 v101, v38, v39
  v_mfma_f32_16x16x32_bf16 v[136:139], a[168:171], v[112:115], v[136:139]
  ds_read_b128 a[136:139], v2 offset:0
  v_exp_f32 v52, v52
  v_mfma_f32_16x16x32_bf16 v[168:171], a[168:171], v[116:119], v[168:171]
  ds_read_b128 a[32:35], v30 offset:8192
  v_fma_f32 v53, v53, s20, v21
  v_fma_f32 v54, v54, s20, v21
  v_mfma_f32_16x16x32_bf16 v[140:143], a[172:175], v[112:115], v[140:143]
  ds_read_b128 a[140:143], v3 offset:0
  v_fma_f32 v55, v55, s20, v21
  v_mfma_f32_16x16x32_bf16 v[172:175], a[172:175], v[116:119], v[172:175]
  ds_read_b128 a[48:51], v30 offset:12288
  v_exp_f32 v53, v53
  v_mfma_f32_16x16x32_bf16 v[144:147], a[176:179], v[112:115], v[144:147]
  ds_read_b128 a[144:147], v0 offset:4096
  v_cvt_pk_bf16_f32 v102, v52, v53
  v_add_u32 v31, s90, v1
  v_mfma_f32_16x16x32_bf16 v[176:179], a[176:179], v[116:119], v[176:179]
  ds_read_b128 a[4:7], v31 offset:0
  v_fma_f32 v40, v40, s20, v22
  v_mfma_f32_16x16x32_bf16 v[148:151], a[180:183], v[112:115], v[148:151]
  ds_read_b128 a[148:151], v1 offset:4096
  v_exp_f32 v54, v54
  v_mfma_f32_16x16x32_bf16 v[180:183], a[180:183], v[116:119], v[180:183]
  ds_read_b128 a[20:23], v31 offset:4096
  v_exp_f32 v55, v55
  v_mfma_f32_16x16x32_bf16 v[152:155], a[184:187], v[112:115], v[152:155]
  ds_read_b128 a[152:155], v2 offset:4096
  v_cvt_pk_bf16_f32 v103, v54, v55
  v_mfma_f32_16x16x32_bf16 v[184:187], a[184:187], v[116:119], v[184:187]
  ds_read_b128 a[36:39], v31 offset:8192
  v_fma_f32 v41, v41, s20, v22
  s_waitcnt lgkmcnt(7)
  v_mfma_f32_16x16x32_bf16 v[156:159], a[188:191], v[112:115], v[156:159]
  ds_read_b128 a[156:159], v3 offset:4096
  v_exp_f32 v40, v40
  v_mfma_f32_16x16x32_bf16 v[188:191], a[188:191], v[116:119], v[188:191]
  ds_read_b128 a[52:55], v31 offset:12288
  v_exp_f32 v41, v41
  v_mfma_f32_16x16x32_bf16 v[192:195], a[160:163], v[120:123], v[192:195]
  v_fma_f32 v42, v42, s20, v22
  v_add_u32 v30, s90, v2
  v_mfma_f32_16x16x32_bf16 v[224:227], a[160:163], v[124:127], v[224:227]
  ds_read_b128 a[8:11], v30 offset:0
  v_exp_f32 v42, v42
  v_mfma_f32_16x16x32_bf16 v[196:199], a[164:167], v[120:123], v[196:199]
  buffer_store_dwordx4 a[228:231], v17, s[12:15], s88 offen offset:1024 nt
  v_mfma_f32_16x16x32_bf16 v[228:231], a[164:167], v[124:127], v[228:231]
  ds_read_b128 a[24:27], v30 offset:4096
  v_cvt_pk_bf16_f32 v104, v40, v41
  v_mfma_f32_16x16x32_bf16 v[200:203], a[168:171], v[120:123], v[200:203]
  v_fma_f32 v43, v43, s20, v22
  v_fma_f32 v56, v56, s20, v22
  v_fma_f32 v57, v57, s20, v22
  v_mfma_f32_16x16x32_bf16 v[232:235], a[168:171], v[124:127], v[232:235]
  ds_read_b128 a[40:43], v30 offset:8192
  v_fma_f32 v58, v58, s20, v22
  v_mfma_f32_16x16x32_bf16 v[204:207], a[172:175], v[120:123], v[204:207]
  buffer_store_dwordx4 a[232:235], v18, s[12:15], s88 offen offset:2048 nt
  v_mfma_f32_16x16x32_bf16 v[236:239], a[172:175], v[124:127], v[236:239]
  ds_read_b128 a[56:59], v30 offset:12288
  v_exp_f32 v43, v43
  v_mfma_f32_16x16x32_bf16 v[208:211], a[176:179], v[120:123], v[208:211]
  v_fma_f32 v59, v59, s20, v22
  v_add_u32 v31, s90, v3
  v_mfma_f32_16x16x32_bf16 v[240:243], a[176:179], v[124:127], v[240:243]
  ds_read_b128 a[12:15], v31 offset:0
  v_cvt_pk_bf16_f32 v105, v42, v43
  v_fma_f32 v44, v44, s20, v23
  v_mfma_f32_16x16x32_bf16 v[212:215], a[180:183], v[120:123], v[212:215]
  buffer_store_dwordx4 a[224:227], v16, s[12:15], s88 offen offset:0 nt
  v_mfma_f32_16x16x32_bf16 v[244:247], a[180:183], v[124:127], v[244:247]
  ds_read_b128 a[28:31], v31 offset:4096
  v_exp_f32 v56, v56
  v_mfma_f32_16x16x32_bf16 v[216:219], a[184:187], v[120:123], v[216:219]
  v_exp_f32 v57, v57
  v_mfma_f32_16x16x32_bf16 v[248:251], a[184:187], v[124:127], v[248:251]
  ds_read_b128 a[44:47], v31 offset:8192
  v_cvt_pk_bf16_f32 v106, v56, v57
  v_mfma_f32_16x16x32_bf16 v[220:223], a[188:191], v[120:123], v[220:223]
  buffer_store_dwordx4 a[236:239], v19, s[12:15], s88 offen offset:3072 nt
  v_mfma_f32_16x16x32_bf16 v[252:255], a[188:191], v[124:127], v[252:255]
  s_waitcnt vmcnt(23) lgkmcnt(3)
  s_barrier
  ds_read_b128 a[60:63], v31 offset:12288
  s_cmp_eq_u32 s21, 3
  s_cbranch_scc1 L_tail
  v_mfma_f32_16x16x32_bf16 v[32:35], a[128:131], a[0:3], 0
  ds_read_b64_tr_b16 a[160:161], v4 offset:8192
  v_fma_f32 v45, v45, s20, v23
  v_mfma_f32_16x16x32_bf16 v[32:35], a[132:135], a[4:7], v[32:35]
  v_exp_f32 v58, v58
  v_mfma_f32_16x16x32_bf16 v[32:35], a[136:139], a[8:11], v[32:35]
  ds_read_b64_tr_b16 a[162:163], v4 offset:12288
  v_fma_f32 v46, v46, s20, v23
  s_waitcnt lgkmcnt(4)
  v_mfma_f32_16x16x32_bf16 v[32:35], a[140:143], a[12:15], v[32:35]
  s_add_u32 s16, s16, 0x2000
  s_and_b32 s16, s16, 0x1ffff
  v_mfma_f32_16x16x32_bf16 v[48:51], a[144:147], a[0:3], 0
  ds_read_b64_tr_b16 a[164:165], v5 offset:8192
  v_fma_f32 v47, v47, s20, v23
  v_mfma_f32_16x16x32_bf16 v[48:51], a[148:151], a[4:7], v[48:51]
  v_fma_f32 v60, v60, s20, v23
  s_add_u32 m0, s19, 0x0
  v_mfma_f32_16x16x32_bf16 v[48:51], a[152:155], a[8:11], v[48:51]
  ds_read_b64_tr_b16 a[166:167], v5 offset:12288
  v_fma_f32 v61, v61, s20, v23
  v_mfma_f32_16x16x32_bf16 v[48:51], a[156:159], a[12:15], v[48:51]
  buffer_load_dwordx4 v12, s[8:11], s16 offen offset:0 nt lds
  v_mfma_f32_16x16x32_bf16 v[36:39], a[128:131], a[16:19], 0
  ds_read_b64_tr_b16 a[168:169], v6 offset:8192
  v_fma_f32 v62, v62, s20, v23
  v_mfma_f32_16x16x32_bf16 v[36:39], a[132:135], a[20:23], v[36:39]
  v_exp_f32 v59, v59
  v_mfma_f32_16x16x32_bf16 v[36:39], a[136:139], a[24:27], v[36:39]
  ds_read_b64_tr_b16 a[170:171], v6 offset:12288
  v_cvt_pk_bf16_f32 v107, v58, v59
  v_fma_f32 v63, v63, s20, v23
  v_mfma_f32_16x16x32_bf16 v[36:39], a[140:143], a[28:31], v[36:39]
  buffer_load_dwordx4 v13, s[8:11], s16 offen offset:1024 nt lds
  v_mfma_f32_16x16x32_bf16 v[52:55], a[144:147], a[16:19], 0
  ds_read_b64_tr_b16 a[172:173], v7 offset:8192
  v_fma_f32 v64, v64, s20, v20
  v_mfma_f32_16x16x32_bf16 v[52:55], a[148:151], a[20:23], v[52:55]
  v_exp_f32 v44, v44
  v_mfma_f32_16x16x32_bf16 v[52:55], a[152:155], a[24:27], v[52:55]
  ds_read_b64_tr_b16 a[174:175], v7 offset:12288
  v_exp_f32 v45, v45
  v_mfma_f32_16x16x32_bf16 v[52:55], a[156:159], a[28:31], v[52:55]
  buffer_load_dwordx4 v14, s[8:11], s16 offen offset:2048 nt lds
  v_mfma_f32_16x16x32_bf16 v[40:43], a[128:131], a[32:35], 0
  ds_read_b64_tr_b16 a[176:177], v8 offset:8192
  v_cvt_pk_bf16_f32 v108, v44, v45
  v_mfma_f32_16x16x32_bf16 v[40:43], a[132:135], a[36:39], v[40:43]
  v_exp_f32 v46, v46
  v_fma_f32 v65, v65, s20, v20
  v_mfma_f32_16x16x32_bf16 v[40:43], a[136:139], a[40:43], v[40:43]
  ds_read_b64_tr_b16 a[178:179], v8 offset:12288
  s_waitcnt lgkmcnt(4)
  v_mfma_f32_16x16x32_bf16 v[40:43], a[140:143], a[44:47], v[40:43]
  buffer_load_dwordx4 v15, s[8:11], s16 offen offset:3072 nt lds
  v_fma_f32 v66, v66, s20, v20
  v_mfma_f32_16x16x32_bf16 v[56:59], a[144:147], a[32:35], 0
  ds_read_b64_tr_b16 a[180:181], v9 offset:8192
  v_fma_f32 v67, v67, s20, v20
  v_mfma_f32_16x16x32_bf16 v[56:59], a[148:151], a[36:39], v[56:59]
  v_exp_f32 v47, v47
  v_mfma_f32_16x16x32_bf16 v[56:59], a[152:155], a[40:43], v[56:59]
  ds_read_b64_tr_b16 a[182:183], v9 offset:12288
  v_cvt_pk_bf16_f32 v109, v46, v47
  v_fma_f32 v80, v80, s20, v20
  v_mfma_f32_16x16x32_bf16 v[56:59], a[156:159], a[44:47], v[56:59]
  v_exp_f32 v60, v60
  v_mfma_f32_16x16x32_bf16 v[44:47], a[128:131], a[48:51], 0
  ds_read_b64_tr_b16 a[184:185], v10 offset:8192
  v_exp_f32 v61, v61
  v_mfma_f32_16x16x32_bf16 v[44:47], a[132:135], a[52:55], v[44:47]
  v_exp_f32 v62, v62
  v_mfma_f32_16x16x32_bf16 v[44:47], a[136:139], a[56:59], v[44:47]
  ds_read_b64_tr_b16 a[186:187], v10 offset:12288
  v_exp_f32 v63, v63
  v_mfma_f32_16x16x32_bf16 v[44:47], a[140:143], a[60:63], v[44:47]
  v_exp_f32 v64, v64
  v_cvt_pk_bf16_f32 v110, v60, v61
  v_cvt_pk_bf16_f32 v111, v62, v63
  v_mfma_f32_16x16x32_bf16 v[60:63], a[144:147], a[48:51], 0
  ds_read_b64_tr_b16 a[188:189], v11 offset:8192
  v_fma_f32 v81, v81, s20, v20
  v_mfma_f32_16x16x32_bf16 v[60:63], a[148:151], a[52:55], v[60:63]
  v_exp_f32 v65, v65
  v_fma_f32 v82, v82, s20, v20
  v_mfma_f32_16x16x32_bf16 v[60:63], a[152:155], a[56:59], v[60:63]
  ds_read_b64_tr_b16 a[190:191], v11 offset:12288
  v_cvt_pk_bf16_f32 v112, v64, v65
  v_mfma_f32_16x16x32_bf16 v[60:63], a[156:159], a[60:63], v[60:63]
  v_exp_f32 v66, v66
  v_mfma_f32_16x16x32_bf16 a[96:99], a[100:103], v[96:99], a[96:99]
  v_exp_f32 v67, v67
  v_fma_f32 v83, v83, s20, v20
  v_mfma_f32_16x16x32_bf16 a[96:99], a[104:107], v[100:103], a[96:99]
  v_exp_f32 v80, v80
  v_mfma_f32_16x16x32_bf16 a[96:99], a[108:111], v[104:107], a[96:99]
  v_exp_f32 v81, v81
  v_mfma_f32_16x16x32_bf16 a[96:99], a[112:115], v[108:111], a[96:99]
  v_cvt_pk_bf16_f32 v113, v66, v67
  v_exp_f32 v82, v82
  v_mfma_f32_16x16x32_bf16 v[128:131], a[160:163], v[96:99], v[128:131]
  ds_read_b128 a[128:131], v0 offset:8192
  v_cvt_pk_bf16_f32 v114, v80, v81
  v_mfma_f32_16x16x32_bf16 v[160:163], a[160:163], v[100:103], v[160:163]
  v_exp_f32 v83, v83
  v_mfma_f32_16x16x32_bf16 v[132:135], a[164:167], v[96:99], v[132:135]
  ds_read_b128 a[132:135], v1 offset:8192
  v_cvt_pk_bf16_f32 v115, v82, v83
  v_fma_f32 v68, v68, s20, v21
  v_mfma_f32_16x16x32_bf16 v[164:167], a[164:167], v[100:103], v[164:167]
  v_exp_f32 v68, v68
  v_mfma_f32_16x16x32_bf16 v[136:139], a[168:171], v[96:99], v[136:139]
  ds_read_b128 a[136:139], v2 offset:8192
  v_fma_f32 v69, v69, s20, v21
  v_fma_f32 v70, v70, s20, v21
  v_mfma_f32_16x16x32_bf16 v[168:171], a[168:171], v[100:103], v[168:171]
  v_fma_f32 v71, v71, s20, v21
  s_waitcnt lgkmcnt(3)
  v_mfma_f32_16x16x32_bf16 v[140:143], a[172:175], v[96:99], v[140:143]
  ds_read_b128 a[140:143], v3 offset:8192
  v_fma_f32 v84, v84, s20, v21
  v_mfma_f32_16x16x32_bf16 v[172:175], a[172:175], v[100:103], v[172:175]
  v_exp_f32 v69, v69
  v_fma_f32 v85, v85, s20, v21
  v_mfma_f32_16x16x32_bf16 v[144:147], a[176:179], v[96:99], v[144:147]
  ds_read_b128 a[144:147], v0 offset:12288
  v_cvt_pk_bf16_f32 v116, v68, v69
  v_mfma_f32_16x16x32_bf16 v[176:179], a[176:179], v[100:103], v[176:179]
  v_exp_f32 v70, v70
  v_mfma_f32_16x16x32_bf16 v[148:151], a[180:183], v[96:99], v[148:151]
  ds_read_b128 a[148:151], v1 offset:12288
  v_exp_f32 v71, v71
  v_mfma_f32_16x16x32_bf16 v[180:183], a[180:183], v[100:103], v[180:183]
  v_exp_f32 v84, v84
  v_mfma_f32_16x16x32_bf16 v[152:155], a[184:187], v[96:99], v[152:155]
  ds_read_b128 a[152:155], v2 offset:12288
  v_cvt_pk_bf16_f32 v117, v70, v71
  v_mfma_f32_16x16x32_bf16 v[184:187], a[184:187], v[100:103], v[184:187]
  v_exp_f32 v85, v85
  v_fma_f32 v86, v86, s20, v21
  v_mfma_f32_16x16x32_bf16 v[156:159], a[188:191], v[96:99], v[156:159]
  ds_read_b128 a[156:159], v3 offset:12288
  v_cvt_pk_bf16_f32 v118, v84, v85
  v_mfma_f32_16x16x32_bf16 v[188:191], a[188:191], v[100:103], v[188:191]
  v_exp_f32 v86, v86
  v_mfma_f32_16x16x32_bf16 v[192:195], a[160:163], v[104:107], v[192:195]
  v_fma_f32 v87, v87, s20, v21
  v_fma_f32 v72, v72, s20, v22
  v_fma_f32 v73, v73, s20, v22
  v_mfma_f32_16x16x32_bf16 v[224:227], a[160:163], v[108:111], v[224:227]
  v_exp_f32 v87, v87
  v_mfma_f32_16x16x32_bf16 v[196:199], a[164:167], v[104:107], v[196:199]
  buffer_store_dwordx4 a[244:247], v17, s[12:15], s89 offen offset:1024 nt
  v_mfma_f32_16x16x32_bf16 v[228:231], a[164:167], v[108:111], v[228:231]
  v_cvt_pk_bf16_f32 v119, v86, v87
  v_exp_f32 v72, v72
  v_mfma_f32_16x16x32_bf16 v[200:203], a[168:171], v[104:107], v[200:203]
  v_exp_f32 v73, v73
  v_mfma_f32_16x16x32_bf16 v[232:235], a[168:171], v[108:111], v[232:235]
  v_fma_f32 v74, v74, s20, v22
  v_cvt_pk_bf16_f32 v120, v72, v73
  v_mfma_f32_16x16x32_bf16 v[204:207], a[172:175], v[104:107], v[204:207]
  v_exp_f32 v74, v74
  v_fma_f32 v75, v75, s20, v22
  v_mfma_f32_16x16x32_bf16 v[236:239], a[172:175], v[108:111], v[236:239]
  v_exp_f32 v75, v75
  v_mfma_f32_16x16x32_bf16 v[208:211], a[176:179], v[104:107], v[208:211]
  v_fma_f32 v88, v88, s20, v22
  v_cvt_pk_bf16_f32 v121, v74, v75
  v_mfma_f32_16x16x32_bf16 v[240:243], a[176:179], v[108:111], v[240:243]
  v_exp_f32 v88, v88
  v_mfma_f32_16x16x32_bf16 v[212:215], a[180:183], v[104:107], v[212:215]
  buffer_store_dwordx4 a[240:243], v16, s[12:15], s89 offen offset:0 nt
  v_mfma_f32_16x16x32_bf16 v[244:247], a[180:183], v[108:111], v[244:247]
  v_fma_f32 v89, v89, s20, v22
  v_fma_f32 v90, v90, s20, v22
  v_mfma_f32_16x16x32_bf16 v[216:219], a[184:187], v[104:107], v[216:219]
  v_exp_f32 v89, v89
  v_mfma_f32_16x16x32_bf16 v[248:251], a[184:187], v[108:111], v[248:251]
  v_exp_f32 v90, v90
  v_mfma_f32_16x16x32_bf16 v[220:223], a[188:191], v[104:107], v[220:223]
  v_cvt_pk_bf16_f32 v122, v88, v89
  v_fma_f32 v91, v91, s20, v22
  v_mfma_f32_16x16x32_bf16 v[252:255], a[188:191], v[108:111], v[252:255]
  s_waitcnt vmcnt(23) lgkmcnt(0)
  s_barrier
  v_mfma_f32_16x16x32_bf16 v[64:67], a[128:131], a[0:3], 0
  ds_read_b64_tr_b16 a[160:161], v4 offset:16384
  v_fma_f32 v76, v76, s20, v23
  v_mfma_f32_16x16x32_bf16 v[64:67], a[132:135], a[4:7], v[64:67]
  v_exp_f32 v91, v91
  v_mfma_f32_16x16x32_bf16 v[64:67], a[136:139], a[8:11], v[64:67]
  ds_read_b64_tr_b16 a[162:163], v4 offset:20480
  v_cvt_pk_bf16_f32 v123, v90, v91
  v_mfma_f32_16x16x32_bf16 v[64:67], a[140:143], a[12:15], v[64:67]
  v_fma_f32 v77, v77, s20, v23
  s_add_u32 s16, s16, 0x2000
  s_and_b32 s16, s16, 0x1ffff
  v_mfma_f32_16x16x32_bf16 v[80:83], a[144:147], a[0:3], 0
  ds_read_b64_tr_b16 a[164:165], v5 offset:16384
  v_fma_f32 v78, v78, s20, v23
  v_mfma_f32_16x16x32_bf16 v[80:83], a[148:151], a[4:7], v[80:83]
  v_exp_f32 v76, v76
  s_add_u32 m0, s19, 0x2000
  v_mfma_f32_16x16x32_bf16 v[80:83], a[152:155], a[8:11], v[80:83]
  ds_read_b64_tr_b16 a[166:167], v5 offset:20480
  v_fma_f32 v79, v79, s20, v23
  v_mfma_f32_16x16x32_bf16 v[80:83], a[156:159], a[12:15], v[80:83]
  buffer_load_dwordx4 v12, s[8:11], s16 offen offset:0 nt lds
  v_fma_f32 v92, v92, s20, v23
  v_mfma_f32_16x16x32_bf16 v[68:71], a[128:131], a[16:19], 0
  ds_read_b64_tr_b16 a[168:169], v6 offset:16384
  v_fma_f32 v93, v93, s20, v23
  v_mfma_f32_16x16x32_bf16 v[68:71], a[132:135], a[20:23], v[68:71]
  v_exp_f32 v77, v77
  v_fma_f32 v94, v94, s20, v23
  v_mfma_f32_16x16x32_bf16 v[68:71], a[136:139], a[24:27], v[68:71]
  ds_read_b64_tr_b16 a[170:171], v6 offset:20480
  v_cvt_pk_bf16_f32 v124, v76, v77
  v_mfma_f32_16x16x32_bf16 v[68:71], a[140:143], a[28:31], v[68:71]
  buffer_load_dwordx4 v13, s[8:11], s16 offen offset:1024 nt lds
  v_fma_f32 v95, v95, s20, v23
  v_mfma_f32_16x16x32_bf16 v[84:87], a[144:147], a[16:19], 0
  ds_read_b64_tr_b16 a[172:173], v7 offset:16384
  v_exp_f32 v78, v78
  v_mfma_f32_16x16x32_bf16 v[84:87], a[148:151], a[20:23], v[84:87]
  v_exp_f32 v79, v79
  v_max3_f32 v24, v32, v33, v34
  v_mfma_f32_16x16x32_bf16 v[84:87], a[152:155], a[24:27], v[84:87]
  ds_read_b64_tr_b16 a[174:175], v7 offset:20480
  v_cvt_pk_bf16_f32 v125, v78, v79
  v_max3_f32 v24, v24, v35, v48
  v_mfma_f32_16x16x32_bf16 v[84:87], a[156:159], a[28:31], v[84:87]
  buffer_load_dwordx4 v14, s[8:11], s16 offen offset:2048 nt lds
  v_mfma_f32_16x16x32_bf16 v[72:75], a[128:131], a[32:35], 0
  ds_read_b64_tr_b16 a[176:177], v8 offset:16384
  v_exp_f32 v92, v92
  v_mfma_f32_16x16x32_bf16 v[72:75], a[132:135], a[36:39], v[72:75]
  v_exp_f32 v93, v93
  v_max3_f32 v24, v24, v49, v50
  v_mfma_f32_16x16x32_bf16 v[72:75], a[136:139], a[40:43], v[72:75]
  ds_read_b64_tr_b16 a[178:179], v8 offset:20480
  v_exp_f32 v94, v94
  v_mfma_f32_16x16x32_bf16 v[72:75], a[140:143], a[44:47], v[72:75]
  buffer_load_dwordx4 v15, s[8:11], s16 offen offset:3072 nt lds
  v_cvt_pk_bf16_f32 v126, v92, v93
  v_mfma_f32_16x16x32_bf16 v[88:91], a[144:147], a[32:35], 0
  ds_read_b64_tr_b16 a[180:181], v9 offset:16384
  v_exp_f32 v95, v95
  v_mfma_f32_16x16x32_bf16 v[88:91], a[148:151], a[36:39], v[88:91]
  v_max_f32 v24, v24, v51
  v_cvt_pk_bf16_f32 v127, v94, v95
  v_mov_b32 v30, v24
  v_mfma_f32_16x16x32_bf16 v[88:91], a[152:155], a[40:43], v[88:91]
  ds_read_b64_tr_b16 a[182:183], v9 offset:20480
  v_permlane16_swap_b32 v30, v24
  v_max3_f32 v25, v36, v37, v38
  v_mfma_f32_16x16x32_bf16 v[88:91], a[156:159], a[44:47], v[88:91]
  v_max_f32 v24, v24, v30
  v_max3_f32 v25, v25, v39, v52
  v_mfma_f32_16x16x32_bf16 v[76:79], a[128:131], a[48:51], 0
  ds_read_b64_tr_b16 a[184:185], v10 offset:16384
  v_mov_b32 v30, v24
  v_max3_f32 v25, v25, v53, v54
  v_mfma_f32_16x16x32_bf16 v[76:79], a[132:135], a[52:55], v[76:79]
  v_permlane32_swap_b32 v30, v24
  v_max_f32 v25, v25, v55
  v_max_f32 v24, v24, v30
  v_mfma_f32_16x16x32_bf16 v[76:79], a[136:139], a[56:59], v[76:79]
  ds_read_b64_tr_b16 a[186:187], v10 offset:20480
  v_mul_f32 v20, s43, v24
  v_mov_b32 v31, v25
  v_mfma_f32_16x16x32_bf16 v[76:79], a[140:143], a[60:63], v[76:79]
  v_fma_f32 v32, v32, s20, v20
  v_fma_f32 v33, v33, s20, v20
  v_exp_f32 v32, v32
  v_mfma_f32_16x16x32_bf16 v[92:95], a[144:147], a[48:51], 0
  ds_read_b64_tr_b16 a[188:189], v11 offset:16384
  v_exp_f32 v33, v33
  v_mfma_f32_16x16x32_bf16 v[92:95], a[148:151], a[52:55], v[92:95]
  v_fma_f32 v34, v34, s20, v20
  v_cvt_pk_bf16_f32 v96, v32, v33
  v_fma_f32 v35, v35, s20, v20
  v_mfma_f32_16x16x32_bf16 v[92:95], a[152:155], a[56:59], v[92:95]
  ds_read_b64_tr_b16 a[190:191], v11 offset:20480
  v_exp_f32 v34, v34
  v_fma_f32 v48, v48, s20, v20
  v_mfma_f32_16x16x32_bf16 v[92:95], a[156:159], a[60:63], v[92:95]
  v_exp_f32 v35, v35
  v_fma_f32 v49, v49, s20, v20
  v_mfma_f32_16x16x32_bf16 a[96:99], a[100:103], v[112:115], a[96:99]
  v_cvt_pk_bf16_f32 v97, v34, v35
  v_exp_f32 v48, v48
  v_fma_f32 v50, v50, s20, v20
  v_mfma_f32_16x16x32_bf16 a[96:99], a[104:107], v[116:119], a[96:99]
  v_exp_f32 v49, v49
  v_exp_f32 v50, v50
  v_mfma_f32_16x16x32_bf16 a[96:99], a[108:111], v[120:123], a[96:99]
  v_cvt_pk_bf16_f32 v98, v48, v49
  v_fma_f32 v51, v51, s20, v20
  v_permlane16_swap_b32 v31, v25
  v_max3_f32 v26, v40, v41, v42
  v_mfma_f32_16x16x32_bf16 a[96:99], a[112:115], v[124:127], a[96:99]
  v_exp_f32 v51, v51
  s_waitcnt lgkmcnt(1)
  v_mfma_f32_16x16x32_bf16 v[128:131], a[160:163], v[112:115], v[128:131]
  ds_read_b128 a[128:131], v0 offset:16384
  v_cvt_pk_bf16_f32 v99, v50, v51
  v_max_f32 v25, v25, v31
  v_max3_f32 v26, v26, v43, v56
  v_mfma_f32_16x16x32_bf16 v[160:163], a[160:163], v[116:119], v[160:163]
  v_mov_b32 v31, v25
  v_max3_f32 v26, v26, v57, v58
  v_max3_f32 v27, v44, v45, v46
  v_permlane32_swap_b32 v31, v25
  v_mfma_f32_16x16x32_bf16 v[132:135], a[164:167], v[112:115], v[132:135]
  ds_read_b128 a[132:135], v1 offset:16384
  v_max_f32 v25, v25, v31
  v_max_f32 v26, v26, v59
  v_mul_f32 v21, s43, v25
  v_mov_b32 v30, v26
  v_mfma_f32_16x16x32_bf16 v[164:167], a[164:167], v[116:119], v[164:167]
  v_fma_f32 v36, v36, s20, v21
  v_fma_f32 v37, v37, s20, v21
  v_exp_f32 v36, v36
  v_mfma_f32_16x16x32_bf16 v[136:139], a[168:171], v[112:115], v[136:139]
  ds_read_b128 a[136:139], v2 offset:16384
  v_exp_f32 v37, v37
  v_fma_f32 v38, v38, s20, v21
  v_mfma_f32_16x16x32_bf16 v[168:171], a[168:171], v[116:119], v[168:171]
  v_exp_f32 v38, v38
  v_cvt_pk_bf16_f32 v100, v36, v37
  v_fma_f32 v39, v39, s20, v21
  v_mfma_f32_16x16x32_bf16 v[140:143], a[172:175], v[112:115], v[140:143]
  ds_read_b128 a[140:143], v3 offset:16384
  v_exp_f32 v39, v39
  v_fma_f32 v52, v52, s20, v21
  v_fma_f32 v53, v53, s20, v21
  v_mfma_f32_16x16x32_bf16 v[172:175], a[172:175], v[116:119], v[172:175]
  v_cvt_pk_bf16_f32 v101, v38, v39
  v_exp_f32 v52, v52
  v_fma_f32 v54, v54, s20, v21
  v_mfma_f32_16x16x32_bf16 v[144:147], a[176:179], v[112:115], v[144:147]
  ds_read_b128 a[144:147], v0 offset:20480
  v_exp_f32 v53, v53
  v_exp_f32 v54, v54
  v_mfma_f32_16x16x32_bf16 v[176:179], a[176:179], v[116:119], v[176:179]
  v_cvt_pk_bf16_f32 v102, v52, v53
  v_fma_f32 v55, v55, s20, v21
  v_permlane16_swap_b32 v30, v26
  v_exp_f32 v55, v55
  v_mfma_f32_16x16x32_bf16 v[148:151], a[180:183], v[112:115], v[148:151]
  ds_read_b128 a[148:151], v1 offset:20480
  v_cvt_pk_bf16_f32 v103, v54, v55
  v_max_f32 v26, v26, v30
  v_max3_f32 v27, v27, v47, v60
  v_mfma_f32_16x16x32_bf16 v[180:183], a[180:183], v[116:119], v[180:183]
  v_mov_b32 v30, v26
  v_max3_f32 v27, v27, v61, v62
  v_fma_f32 v64, v64, s20, v20
  v_permlane32_swap_b32 v30, v26
  v_max_f32 v27, v27, v63
  v_mfma_f32_16x16x32_bf16 v[152:155], a[184:187], v[112:115], v[152:155]
  ds_read_b128 a[152:155], v2 offset:20480
  v_max_f32 v26, v26, v30
  v_mov_b32 v31, v27
  v_mul_f32 v22, s43, v26
  v_accvgpr_read_b32 v30, a96
  v_mfma_f32_16x16x32_bf16 v[184:187], a[184:187], v[116:119], v[184:187]
  v_fma_f32 v40, v40, s20, v22
  v_fma_f32 v41, v41, s20, v22
  v_exp_f32 v40, v40
  s_waitcnt lgkmcnt(3)
  v_mfma_f32_16x16x32_bf16 v[156:159], a[188:191], v[112:115], v[156:159]
  ds_read_b128 a[156:159], v3 offset:20480
  v_exp_f32 v41, v41
  v_fma_f32 v42, v42, s20, v22
  v_fma_f32 v43, v43, s20, v22
  v_mfma_f32_16x16x32_bf16 v[188:191], a[188:191], v[116:119], v[188:191]
  v_exp_f32 v42, v42
  v_exp_f32 v43, v43
  v_cvt_pk_bf16_f32 v104, v40, v41
  v_mfma_f32_16x16x32_bf16 v[192:195], a[160:163], v[120:123], v[192:195]
  v_cvt_pk_bf16_f32 v105, v42, v43
  v_fma_f32 v56, v56, s20, v22
  v_fma_f32 v57, v57, s20, v22
  v_exp_f32 v56, v56
  v_mfma_f32_16x16x32_bf16 v[224:227], a[160:163], v[124:127], v[224:227]
  v_exp_f32 v57, v57
  v_fma_f32 v58, v58, s20, v22
  v_fma_f32 v59, v59, s20, v22
  v_cvt_pk_bf16_f32 v106, v56, v57
  v_mfma_f32_16x16x32_bf16 v[196:199], a[164:167], v[120:123], v[196:199]
  buffer_store_dwordx4 a[252:255], v19, s[12:15], s89 offen offset:3072 nt
  v_mfma_f32_16x16x32_bf16 v[228:231], a[164:167], v[124:127], v[228:231]
  v_exp_f32 v58, v58
  v_exp_f32 v59, v59
  v_permlane16_swap_b32 v31, v27
  v_mfma_f32_16x16x32_bf16 v[200:203], a[168:171], v[120:123], v[200:203]
  v_cvt_pk_bf16_f32 v107, v58, v59
  v_max_f32 v27, v27, v31
  v_rcp_f32 v24, v30
  v_mov_b32 v31, v27
  v_cmp_nle_f32 s[30:31], v30, s25
  v_accvgpr_read_b32 v30, a98
  v_mfma_f32_16x16x32_bf16 v[232:235], a[168:171], v[124:127], v[232:235]
  v_permlane32_swap_b32 v31, v27
  v_mul_f32 v128, v128, v24
  v_max_f32 v27, v27, v31
  v_accvgpr_read_b32 v31, a97
  v_mul_f32 v23, s43, v27
  v_rcp_f32 v25, v31
  v_mfma_f32_16x16x32_bf16 v[204:207], a[172:175], v[120:123], v[204:207]
  v_fma_f32 v44, v44, s20, v23
  v_fma_f32 v45, v45, s20, v23
  v_exp_f32 v44, v44
  v_exp_f32 v45, v45
  v_fma_f32 v46, v46, s20, v23
  v_mfma_f32_16x16x32_bf16 v[236:239], a[172:175], v[124:127], v[236:239]
  v_exp_f32 v46, v46
  v_cvt_pk_bf16_f32 v108, v44, v45
  v_fma_f32 v47, v47, s20, v23
  v_fma_f32 v60, v60, s20, v23
  v_fma_f32 v61, v61, s20, v23
  v_mfma_f32_16x16x32_bf16 v[208:211], a[176:179], v[120:123], v[208:211]
  v_exp_f32 v47, v47
  v_exp_f32 v60, v60
  v_cvt_pk_bf16_f32 v109, v46, v47
  v_exp_f32 v61, v61
  v_mfma_f32_16x16x32_bf16 v[240:243], a[176:179], v[124:127], v[240:243]
  v_fma_f32 v62, v62, s20, v23
  v_cvt_pk_bf16_f32 v110, v60, v61
  v_exp_f32 v62, v62
  v_fma_f32 v63, v63, s20, v23
  v_cmp_nle_f32 s[44:45], v31, s25
  v_accvgpr_read_b32 v31, a99
  v_mfma_f32_16x16x32_bf16 v[212:215], a[180:183], v[120:123], v[212:215]
  buffer_store_dwordx4 a[248:251], v18, s[12:15], s89 offen offset:2048 nt
  v_mul_f32 v129, v129, v24
  v_mfma_f32_16x16x32_bf16 v[244:247], a[180:183], v[124:127], v[244:247]
  v_exp_f32 v63, v63
  v_mul_f32 v130, v130, v24
  v_mul_f32 v131, v131, v24
  v_cvt_pk_bf16_f32 v111, v62, v63
  v_cvt_pk_bf16_f32 v128, v128, v129
  v_cvt_pk_bf16_f32 v129, v130, v131
  v_mfma_f32_16x16x32_bf16 v[216:219], a[184:187], v[120:123], v[216:219]
  ds_write_b64 v28, v[128:129] offset:0
  v_mul_f32 v160, v160, v25
  v_mul_f32 v161, v161, v25
  v_mul_f32 v162, v162, v25
  v_mul_f32 v163, v163, v25
  v_mfma_f32_16x16x32_bf16 v[248:251], a[184:187], v[124:127], v[248:251]
  v_cvt_pk_bf16_f32 v160, v160, v161
  v_cvt_pk_bf16_f32 v161, v162, v163
  v_rcp_f32 v26, v30
  s_or_b64 s[30:31], s[30:31], s[44:45]
  v_cmp_nle_f32 s[44:45], v30, s25
  v_xor_b32 v30, 32, v28
  v_mfma_f32_16x16x32_bf16 v[220:223], a[188:191], v[120:123], v[220:223]
  ds_write_b64 v28, v[160:161] offset:4096
  v_mul_f32 v132, v132, v24
  v_mul_f32 v133, v133, v24
  v_mul_f32 v134, v134, v24
  v_mul_f32 v135, v135, v24
  v_mfma_f32_16x16x32_bf16 v[252:255], a[188:191], v[124:127], v[252:255]
  s_waitcnt vmcnt(23) lgkmcnt(2)
  s_barrier
  v_mfma_f32_16x16x32_bf16 v[32:35], a[128:131], a[0:3], 0
  ds_read_b64_tr_b16 a[160:161], v4 offset:24576
  v_cvt_pk_bf16_f32 v132, v132, v133
  v_cvt_pk_bf16_f32 v133, v134, v135
  v_mul_f32 v164, v164, v25
  v_mul_f32 v165, v165, v25
  v_mul_f32 v166, v166, v25
  v_mfma_f32_16x16x32_bf16 v[32:35], a[132:135], a[4:7], v[32:35]
  ds_write_b64 v30, v[132:133] offset:0
  v_mul_f32 v167, v167, v25
  s_add_u32 s12, s12, 0xf80000
  s_addc_u32 s13, s13, 0
  s_mov_b32 s14, s91
  v_mfma_f32_16x16x32_bf16 v[32:35], a[136:139], a[8:11], v[32:35]
  ds_read_b64_tr_b16 a[162:163], v4 offset:28672
  v_cvt_pk_bf16_f32 v164, v164, v165
  v_cvt_pk_bf16_f32 v165, v166, v167
  v_rcp_f32 v27, v31
  s_or_b64 s[30:31], s[30:31], s[44:45]
  v_cmp_nle_f32 s[44:45], v31, s25
  v_mfma_f32_16x16x32_bf16 v[32:35], a[140:143], a[12:15], v[32:35]
  ds_write_b64 v30, v[164:165] offset:4096
  v_xor_b32 v31, 64, v28
  v_mul_f32 v136, v136, v24
  s_add_u32 s16, s16, 0x2000
  s_and_b32 s16, s16, 0x1ffff
  v_mfma_f32_16x16x32_bf16 v[48:51], a[144:147], a[0:3], 0
  ds_read_b64_tr_b16 a[164:165], v5 offset:24576
  v_mul_f32 v137, v137, v24
  v_mul_f32 v138, v138, v24
  v_mul_f32 v139, v139, v24
  v_cvt_pk_bf16_f32 v136, v136, v137
  v_cvt_pk_bf16_f32 v137, v138, v139
  v_mul_f32 v168, v168, v25
  v_mfma_f32_16x16x32_bf16 v[48:51], a[148:151], a[4:7], v[48:51]
  ds_write_b64 v31, v[136:137] offset:0
  v_mul_f32 v169, v169, v25
  v_mul_f32 v170, v170, v25
  v_mul_f32 v171, v171, v25
  s_add_u32 m0, s19, 0x4000
  v_mfma_f32_16x16x32_bf16 v[48:51], a[152:155], a[8:11], v[48:51]
  ds_read_b64_tr_b16 a[166:167], v5 offset:28672
  v_cvt_pk_bf16_f32 v168, v168, v169
  v_cvt_pk_bf16_f32 v169, v170, v171
  v_xor_b32 v30, 96, v28
  v_mul_f32 v140, v140, v24
  v_mul_f32 v141, v141, v24
  v_mul_f32 v142, v142, v24
  v_mfma_f32_16x16x32_bf16 v[48:51], a[156:159], a[12:15], v[48:51]
  buffer_load_dwordx4 v12, s[8:11], s16 offen offset:0 nt lds
  ds_write_b64 v31, v[168:169] offset:4096
  v_mul_f32 v143, v143, v24
  v_cvt_pk_bf16_f32 v140, v140, v141
  v_mfma_f32_16x16x32_bf16 v[36:39], a[128:131], a[16:19], 0
  ds_read_b64_tr_b16 a[168:169], v6 offset:24576
  v_cvt_pk_bf16_f32 v141, v142, v143
  v_mul_f32 v172, v172, v25
  v_mul_f32 v173, v173, v25
  v_mul_f32 v174, v174, v25
  v_mul_f32 v175, v175, v25
  v_cvt_pk_bf16_f32 v172, v172, v173
  v_mfma_f32_16x16x32_bf16 v[36:39], a[132:135], a[20:23], v[36:39]
  ds_write_b64 v30, v[140:141] offset:0
  v_cvt_pk_bf16_f32 v173, v174, v175
  v_xor_b32 v31, 128, v28
  v_mul_f32 v144, v144, v24
  v_mfma_f32_16x16x32_bf16 v[36:39], a[136:139], a[24:27], v[36:39]
  ds_read_b64_tr_b16 a[170:171], v6 offset:28672
  ds_write_b64 v30, v[172:173] offset:4096
  v_mul_f32 v145, v145, v24
  v_mul_f32 v146, v146, v24
  v_mul_f32 v147, v147, v24
  v_mfma_f32_16x16x32_bf16 v[36:39], a[140:143], a[28:31], v[36:39]
  buffer_load_dwordx4 v13, s[8:11], s16 offen offset:1024 nt lds
  v_cvt_pk_bf16_f32 v144, v144, v145
  v_cvt_pk_bf16_f32 v145, v146, v147
  v_mul_f32 v176, v176, v25
  v_mul_f32 v177, v177, v25
  v_mul_f32 v178, v178, v25
  v_mfma_f32_16x16x32_bf16 v[52:55], a[144:147], a[16:19], 0
  ds_read_b64_tr_b16 a[172:173], v7 offset:24576
  ds_write_b64 v31, v[144:145] offset:0
  v_mul_f32 v179, v179, v25
  v_cvt_pk_bf16_f32 v176, v176, v177
  v_cvt_pk_bf16_f32 v177, v178, v179
  v_mfma_f32_16x16x32_bf16 v[52:55], a[148:151], a[20:23], v[52:55]
  ds_write_b64 v31, v[176:177] offset:4096
  v_xor_b32 v30, 160, v28
  v_mul_f32 v148, v148, v24
  v_mul_f32 v149, v149, v24
  v_mul_f32 v150, v150, v24
  v_mfma_f32_16x16x32_bf16 v[52:55], a[152:155], a[24:27], v[52:55]
  ds_read_b64_tr_b16 a[174:175], v7 offset:28672
  v_mul_f32 v151, v151, v24
  v_cvt_pk_bf16_f32 v148, v148, v149
  v_cvt_pk_bf16_f32 v149, v150, v151
  v_mul_f32 v180, v180, v25
  v_mul_f32 v181, v181, v25
  v_mul_f32 v182, v182, v25
  v_mfma_f32_16x16x32_bf16 v[52:55], a[156:159], a[28:31], v[52:55]
  buffer_load_dwordx4 v14, s[8:11], s16 offen offset:2048 nt lds
  ds_write_b64 v30, v[148:149] offset:0
  v_mul_f32 v183, v183, v25
  v_cvt_pk_bf16_f32 v180, v180, v181
  v_mfma_f32_16x16x32_bf16 v[40:43], a[128:131], a[32:35], 0
  ds_read_b64_tr_b16 a[176:177], v8 offset:24576
  v_cvt_pk_bf16_f32 v181, v182, v183
  v_xor_b32 v31, 192, v28
  v_mul_f32 v152, v152, v24
  v_mul_f32 v153, v153, v24
  v_mul_f32 v154, v154, v24
  v_mul_f32 v155, v155, v24
  v_mfma_f32_16x16x32_bf16 v[40:43], a[132:135], a[36:39], v[40:43]
  ds_write_b64 v30, v[180:181] offset:4096
  v_cvt_pk_bf16_f32 v152, v152, v153
  v_cvt_pk_bf16_f32 v153, v154, v155
  v_mul_f32 v184, v184, v25
  v_mul_f32 v185, v185, v25
  v_mfma_f32_16x16x32_bf16 v[40:43], a[136:139], a[40:43], v[40:43]
  ds_read_b64_tr_b16 a[178:179], v8 offset:28672
  ds_write_b64 v31, v[152:153] offset:0
  v_mul_f32 v186, v186, v25
  v_mul_f32 v187, v187, v25
  v_mfma_f32_16x16x32_bf16 v[40:43], a[140:143], a[44:47], v[40:43]
  buffer_load_dwordx4 v15, s[8:11], s16 offen offset:3072 nt lds
  v_cvt_pk_bf16_f32 v184, v184, v185
  v_cvt_pk_bf16_f32 v185, v186, v187
  v_xor_b32 v30, 224, v28
  v_mul_f32 v156, v156, v24
  v_mul_f32 v157, v157, v24
  v_mfma_f32_16x16x32_bf16 v[56:59], a[144:147], a[32:35], 0
  ds_read_b64_tr_b16 a[180:181], v9 offset:24576
  ds_write_b64 v31, v[184:185] offset:4096
  v_mul_f32 v158, v158, v24
  v_mul_f32 v159, v159, v24
  v_cvt_pk_bf16_f32 v156, v156, v157
  v_mfma_f32_16x16x32_bf16 v[56:59], a[148:151], a[36:39], v[56:59]
  v_cvt_pk_bf16_f32 v157, v158, v159
  v_mul_f32 v188, v188, v25
  v_mul_f32 v189, v189, v25
  v_mul_f32 v190, v190, v25
  v_mul_f32 v191, v191, v25
  v_cvt_pk_bf16_f32 v188, v188, v189
  v_cvt_pk_bf16_f32 v189, v190, v191
  v_mfma_f32_16x16x32_bf16 v[56:59], a[152:155], a[40:43], v[56:59]
  ds_read_b64_tr_b16 a[182:183], v9 offset:28672
  ds_write_b64 v30, v[156:157] offset:0
  v_mul_f32 v192, v192, v26
  v_mul_f32 v193, v193, v26
  v_mul_f32 v194, v194, v26
  v_mfma_f32_16x16x32_bf16 v[56:59], a[156:159], a[44:47], v[56:59]
  ds_write_b64 v30, v[188:189] offset:4096
  v_mul_f32 v195, v195, v26
  v_cvt_pk_bf16_f32 v192, v192, v193
  v_cvt_pk_bf16_f32 v193, v194, v195
  v_mul_f32 v224, v224, v27
  v_mfma_f32_16x16x32_bf16 v[44:47], a[128:131], a[48:51], 0
  ds_read_b64_tr_b16 a[184:185], v10 offset:24576
  ds_write_b64 v28, v[192:193] offset:8192
  v_mul_f32 v225, v225, v27
  v_mul_f32 v226, v226, v27
  v_mul_f32 v227, v227, v27
  v_mfma_f32_16x16x32_bf16 v[44:47], a[132:135], a[52:55], v[44:47]
  ds_read_b128 a[192:195], v29 offset:0
  v_cvt_pk_bf16_f32 v224, v224, v225
  v_cvt_pk_bf16_f32 v225, v226, v227
  s_or_b64 s[30:31], s[30:31], s[44:45]
  s_cmp_lg_u64 s[30:31], 0
  s_cselect_b32 s27, s46, 0
  s_or_b32 s24, s24, s27
  v_mfma_f32_16x16x32_bf16 v[44:47], a[136:139], a[56:59], v[44:47]
  ds_read_b64_tr_b16 a[186:187], v10 offset:28672
  ds_write_b64 v28, v[224:225] offset:12288
  v_xor_b32 v31, 32, v28
  v_mul_f32 v196, v196, v26
  v_mul_f32 v197, v197, v26
  v_mfma_f32_16x16x32_bf16 v[44:47], a[140:143], a[60:63], v[44:47]
  ds_read_b128 a[196:199], v29 offset:1024
  v_mul_f32 v198, v198, v26
  v_mul_f32 v199, v199, v26
  v_cvt_pk_bf16_f32 v196, v196, v197
  v_cvt_pk_bf16_f32 v197, v198, v199
  v_mul_f32 v228, v228, v27
  v_mfma_f32_16x16x32_bf16 v[60:63], a[144:147], a[48:51], 0
  ds_read_b64_tr_b16 a[188:189], v11 offset:24576
  ds_write_b64 v31, v[196:197] offset:8192
  v_mul_f32 v229, v229, v27
  v_mul_f32 v230, v230, v27
  v_mul_f32 v231, v231, v27
  v_mfma_f32_16x16x32_bf16 v[60:63], a[148:151], a[52:55], v[60:63]
  ds_read_b128 a[200:203], v29 offset:2048
  v_cvt_pk_bf16_f32 v228, v228, v229
  v_cvt_pk_bf16_f32 v229, v230, v231
  v_xor_b32 v30, 64, v28
  v_mul_f32 v200, v200, v26
  v_mul_f32 v201, v201, v26
  v_mul_f32 v202, v202, v26
  v_mfma_f32_16x16x32_bf16 v[60:63], a[152:155], a[56:59], v[60:63]
  ds_read_b64_tr_b16 a[190:191], v11 offset:28672
  ds_write_b64 v31, v[228:229] offset:12288
  v_mul_f32 v203, v203, v26
  v_cvt_pk_bf16_f32 v200, v200, v201
  v_cvt_pk_bf16_f32 v201, v202, v203
  v_mfma_f32_16x16x32_bf16 v[60:63], a[156:159], a[60:63], v[60:63]
  ds_write_b64 v30, v[200:201] offset:8192
  v_mul_f32 v232, v232, v27
  v_mul_f32 v233, v233, v27
  v_mul_f32 v234, v234, v27
  v_mul_f32 v235, v235, v27
  v_mfma_f32_16x16x32_bf16 a[96:99], a[100:103], v[96:99], 0
  ds_read_b128 a[204:207], v29 offset:3072
  v_cvt_pk_bf16_f32 v232, v232, v233
  v_cvt_pk_bf16_f32 v233, v234, v235
  v_xor_b32 v31, 96, v28
  v_mul_f32 v204, v204, v26
  v_mul_f32 v205, v205, v26
  v_mul_f32 v206, v206, v26
  v_mfma_f32_16x16x32_bf16 a[96:99], a[104:107], v[100:103], a[96:99]
  ds_write_b64 v30, v[232:233] offset:12288
  v_mul_f32 v207, v207, v26
  v_cvt_pk_bf16_f32 v204, v204, v205
  v_cvt_pk_bf16_f32 v205, v206, v207
  v_mul_f32 v236, v236, v27
  v_mfma_f32_16x16x32_bf16 a[96:99], a[108:111], v[104:107], a[96:99]
  ds_write_b64 v31, v[204:205] offset:8192
  v_mul_f32 v237, v237, v27
  v_mul_f32 v238, v238, v27
  v_mul_f32 v239, v239, v27
  v_cvt_pk_bf16_f32 v236, v236, v237
  v_mfma_f32_16x16x32_bf16 a[96:99], a[112:115], v[108:111], a[96:99]
  ds_read_b128 a[208:211], v29 offset:4096
  v_cvt_pk_bf16_f32 v237, v238, v239
  v_xor_b32 v30, 128, v28
  v_mul_f32 v208, v208, v26
  v_mul_f32 v209, v209, v26
  v_mul_f32 v210, v210, v26
  s_waitcnt lgkmcnt(9)
  v_mfma_f32_16x16x32_bf16 v[128:131], a[160:163], v[96:99], 0
  ds_read_b128 a[128:131], v0 offset:24576
  v_mul_f32 v211, v211, v26
  v_cvt_pk_bf16_f32 v208, v208, v209
  v_cvt_pk_bf16_f32 v209, v210, v211
  v_mul_f32 v240, v240, v27
  v_mul_f32 v241, v241, v27
  v_mfma_f32_16x16x32_bf16 v[160:163], a[160:163], v[100:103], 0
  ds_write_b64 v31, v[236:237] offset:12288
  v_mul_f32 v242, v242, v27
  v_mul_f32 v243, v243, v27
  v_cvt_pk_bf16_f32 v240, v240, v241
  v_cvt_pk_bf16_f32 v241, v242, v243
  v_mfma_f32_16x16x32_bf16 v[132:135], a[164:167], v[96:99], 0
  ds_read_b128 a[132:135], v1 offset:24576
  v_xor_b32 v31, 160, v28
  v_mul_f32 v212, v212, v26
  v_mul_f32 v213, v213, v26
  v_mul_f32 v214, v214, v26
  v_mul_f32 v215, v215, v26
  v_cvt_pk_bf16_f32 v212, v212, v213
  v_mfma_f32_16x16x32_bf16 v[164:167], a[164:167], v[100:103], 0
  ds_write_b64 v30, v[208:209] offset:8192
  v_cvt_pk_bf16_f32 v213, v214, v215
  v_mul_f32 v244, v244, v27
  v_mul_f32 v245, v245, v27
  v_mul_f32 v246, v246, v27
  v_mfma_f32_16x16x32_bf16 v[136:139], a[168:171], v[96:99], 0
  ds_read_b128 a[136:139], v2 offset:24576
  v_mul_f32 v247, v247, v27
  v_cvt_pk_bf16_f32 v244, v244, v245
  v_cvt_pk_bf16_f32 v245, v246, v247
  v_mul_f32 v216, v216, v26
  v_mul_f32 v217, v217, v26
  v_mul_f32 v218, v218, v26
  v_mfma_f32_16x16x32_bf16 v[168:171], a[168:171], v[100:103], 0
  ds_write_b64 v30, v[240:241] offset:12288
  v_xor_b32 v30, 192, v28
  v_mul_f32 v219, v219, v26
  v_cvt_pk_bf16_f32 v216, v216, v217
  v_cvt_pk_bf16_f32 v217, v218, v219
  v_mfma_f32_16x16x32_bf16 v[140:143], a[172:175], v[96:99], 0
  ds_read_b128 a[140:143], v3 offset:24576
  v_mul_f32 v248, v248, v27
  v_mul_f32 v249, v249, v27
  v_mul_f32 v250, v250, v27
  v_mul_f32 v251, v251, v27
  v_cvt_pk_bf16_f32 v248, v248, v249
  v_cvt_pk_bf16_f32 v249, v250, v251
  v_mfma_f32_16x16x32_bf16 v[172:175], a[172:175], v[100:103], 0
  ds_write_b64 v31, v[212:213] offset:8192
  v_mul_f32 v220, v220, v26
  v_mul_f32 v221, v221, v26
  v_mul_f32 v222, v222, v26
  v_mul_f32 v223, v223, v26
  v_mfma_f32_16x16x32_bf16 v[144:147], a[176:179], v[96:99], 0
  ds_read_b128 a[144:147], v0 offset:28672
  v_cvt_pk_bf16_f32 v220, v220, v221
  v_cvt_pk_bf16_f32 v221, v222, v223
  v_mul_f32 v252, v252, v27
  v_mul_f32 v253, v253, v27
  v_mul_f32 v254, v254, v27
  v_mul_f32 v255, v255, v27
  v_mfma_f32_16x16x32_bf16 v[176:179], a[176:179], v[100:103], 0
  ds_write_b64 v31, v[244:245] offset:12288
  v_xor_b32 v31, 224, v28
  v_cvt_pk_bf16_f32 v252, v252, v253
  v_cvt_pk_bf16_f32 v253, v254, v255
  v_mfma_f32_16x16x32_bf16 v[148:151], a[180:183], v[96:99], 0
  ds_read_b128 a[148:151], v1 offset:28672
  v_exp_f32 v64, v64
  v_fma_f32 v65, v65, s20, v20
  v_fma_f32 v66, v66, s20, v20
  v_exp_f32 v65, v65
  v_mfma_f32_16x16x32_bf16 v[180:183], a[180:183], v[100:103], 0
  ds_write_b64 v30, v[216:217] offset:8192
  v_exp_f32 v66, v66
  v_cvt_pk_bf16_f32 v112, v64, v65
  v_fma_f32 v67, v67, s20, v20
  v_mfma_f32_16x16x32_bf16 v[152:155], a[184:187], v[96:99], 0
  ds_read_b128 a[152:155], v2 offset:28672
  v_exp_f32 v67, v67
  v_fma_f32 v80, v80, s20, v20
  v_fma_f32 v81, v81, s20, v20
  v_exp_f32 v80, v80
  v_mfma_f32_16x16x32_bf16 v[184:187], a[184:187], v[100:103], 0
  ds_write_b64 v30, v[248:249] offset:12288
  v_exp_f32 v81, v81
  v_cvt_pk_bf16_f32 v113, v66, v67
  s_waitcnt lgkmcnt(7)
  v_mfma_f32_16x16x32_bf16 v[156:159], a[188:191], v[96:99], 0
  ds_read_b128 a[156:159], v3 offset:28672
  v_cvt_pk_bf16_f32 v114, v80, v81
  v_fma_f32 v82, v82, s20, v20
  v_fma_f32 v83, v83, s20, v20
  v_exp_f32 v82, v82
  v_fma_f32 v68, v68, s20, v21
  v_mfma_f32_16x16x32_bf16 v[188:191], a[188:191], v[100:103], 0
  ds_write_b64 v31, v[220:221] offset:8192
  v_exp_f32 v83, v83
  v_exp_f32 v68, v68
  v_mfma_f32_16x16x32_bf16 v[192:195], a[160:163], v[104:107], 0
  ds_write_b64 v31, v[252:253] offset:12288
  v_cvt_pk_bf16_f32 v115, v82, v83
  v_fma_f32 v69, v69, s20, v21
  v_fma_f32 v70, v70, s20, v21
  v_fma_f32 v71, v71, s20, v21
  v_mfma_f32_16x16x32_bf16 v[224:227], a[160:163], v[108:111], 0
  ds_read_b128 a[212:215], v29 offset:5120
  v_exp_f32 v69, v69
  v_exp_f32 v70, v70
  s_add_u32 s21, s21, 1
  s_lshl_b32 s46, s46, 1
  v_mfma_f32_16x16x32_bf16 v[196:199], a[164:167], v[104:107], 0
  ds_read_b128 a[216:219], v29 offset:6144
  v_exp_f32 v71, v71
  v_cvt_pk_bf16_f32 v116, v68, v69
  v_fma_f32 v84, v84, s20, v21
  v_cvt_pk_bf16_f32 v117, v70, v71
  v_mfma_f32_16x16x32_bf16 v[228:231], a[164:167], v[108:111], 0
  ds_read_b128 a[220:223], v29 offset:7168
  v_exp_f32 v84, v84
  v_fma_f32 v85, v85, s20, v21
  s_cmp_eq_u32 s21, 3
  s_cselect_b32 s23, 0, s42
  s_cselect_b32 s6, 0, s91
  v_mfma_f32_16x16x32_bf16 v[200:203], a[168:171], v[104:107], 0
  ds_read_b128 a[224:227], v29 offset:8192
  v_exp_f32 v85, v85
  v_fma_f32 v86, v86, s20, v21
  v_fma_f32 v87, v87, s20, v21
  v_exp_f32 v86, v86
  v_mfma_f32_16x16x32_bf16 v[232:235], a[168:171], v[108:111], 0
  ds_read_b128 a[228:231], v29 offset:9216
  v_exp_f32 v87, v87
  v_cvt_pk_bf16_f32 v118, v84, v85
  v_fma_f32 v72, v72, s20, v22
  s_cmp_lt_u32 s26, 2
  s_cselect_b32 s22, s23, s42
  v_mfma_f32_16x16x32_bf16 v[204:207], a[172:175], v[104:107], 0
  ds_read_b128 a[232:235], v29 offset:10240
  v_exp_f32 v72, v72
  v_cvt_pk_bf16_f32 v119, v86, v87
  v_fma_f32 v73, v73, s20, v22
  v_fma_f32 v74, v74, s20, v22
  v_fma_f32 v75, v75, s20, v22
  v_mfma_f32_16x16x32_bf16 v[236:239], a[172:175], v[108:111], 0
  ds_read_b128 a[236:239], v29 offset:11264
  v_exp_f32 v73, v73
  v_exp_f32 v74, v74
  v_exp_f32 v75, v75
  v_mfma_f32_16x16x32_bf16 v[208:211], a[176:179], v[104:107], 0
  ds_read_b128 a[240:243], v29 offset:12288
  v_cvt_pk_bf16_f32 v120, v72, v73
  v_cvt_pk_bf16_f32 v121, v74, v75
  v_fma_f32 v88, v88, s20, v22
  v_fma_f32 v89, v89, s20, v22
  v_exp_f32 v88, v88
  v_mfma_f32_16x16x32_bf16 v[240:243], a[176:179], v[108:111], 0
  ds_read_b128 a[244:247], v29 offset:13312
  v_exp_f32 v89, v89
  v_fma_f32 v90, v90, s20, v22
  v_fma_f32 v91, v91, s20, v22
  v_exp_f32 v90, v90
  v_mfma_f32_16x16x32_bf16 v[212:215], a[180:183], v[104:107], 0
  ds_read_b128 a[248:251], v29 offset:14336
  v_exp_f32 v91, v91
  v_cvt_pk_bf16_f32 v122, v88, v89
  v_fma_f32 v76, v76, s20, v23
  v_cvt_pk_bf16_f32 v123, v90, v91
  v_fma_f32 v77, v77, s20, v23
  v_mfma_f32_16x16x32_bf16 v[244:247], a[180:183], v[108:111], 0
  ds_read_b128 a[252:255], v29 offset:15360
  v_exp_f32 v76, v76
  v_exp_f32 v77, v77
  v_fma_f32 v78, v78, s20, v23
  v_mfma_f32_16x16x32_bf16 v[216:219], a[184:187], v[104:107], 0
  v_exp_f32 v78, v78
  v_cvt_pk_bf16_f32 v124, v76, v77
  v_fma_f32 v79, v79, s20, v23
  v_fma_f32 v92, v92, s20, v23
  v_exp_f32 v79, v79
  v_mfma_f32_16x16x32_bf16 v[248:251], a[184:187], v[108:111], 0
  v_exp_f32 v92, v92
  v_cvt_pk_bf16_f32 v125, v78, v79
  v_fma_f32 v93, v93, s20, v23
  v_fma_f32 v94, v94, s20, v23
  v_exp_f32 v93, v93
  v_mfma_f32_16x16x32_bf16 v[220:223], a[188:191], v[104:107], 0
  v_exp_f32 v94, v94
  v_cvt_pk_bf16_f32 v126, v92, v93
  v_fma_f32 v95, v95, s20, v23
  v_exp_f32 v95, v95
  v_mfma_f32_16x16x32_bf16 v[252:255], a[188:191], v[108:111], 0
  s_waitcnt vmcnt(20) lgkmcnt(13)
  s_barrier
  v_cvt_pk_bf16_f32 v127, v94, v95
  s_branch L_loop
L_tail:
  ds_read_b64_tr_b16 a[160:161], v4 offset:8192
  ds_read_b64_tr_b16 a[162:163], v4 offset:12288
  ds_read_b64_tr_b16 a[164:165], v5 offset:8192
  ds_read_b64_tr_b16 a[166:167], v5 offset:12288
  ds_read_b64_tr_b16 a[168:169], v6 offset:8192
  ds_read_b64_tr_b16 a[170:171], v6 offset:12288
  ds_read_b64_tr_b16 a[172:173], v7 offset:8192
  ds_read_b64_tr_b16 a[174:175], v7 offset:12288
  ds_read_b64_tr_b16 a[176:177], v8 offset:8192
  ds_read_b64_tr_b16 a[178:179], v8 offset:12288
  ds_read_b64_tr_b16 a[180:181], v9 offset:8192
  ds_read_b64_tr_b16 a[182:183], v9 offset:12288
  ds_read_b64_tr_b16 a[184:185], v10 offset:8192
  ds_read_b64_tr_b16 a[186:187], v10 offset:12288
  ds_read_b64_tr_b16 a[188:189], v11 offset:8192
  ds_read_b64_tr_b16 a[190:191], v11 offset:12288
  s_waitcnt vmcnt(17)
  s_barrier
  v_exp_f32 v58, v58
  v_exp_f32 v59, v59
  v_exp_f32 v44, v44
  v_cvt_pk_bf16_f32 v107, v58, v59
  v_fma_f32 v45, v45, s20, v23
  v_fma_f32 v46, v46, s20, v23
  v_exp_f32 v45, v45
  v_exp_f32 v46, v46
  v_cvt_pk_bf16_f32 v108, v44, v45
  v_fma_f32 v47, v47, s20, v23
  v_mfma_f32_16x16x32_bf16 a[96:99], a[100:103], v[96:99], a[96:99]
  v_exp_f32 v47, v47
  v_fma_f32 v60, v60, s20, v23
  v_fma_f32 v61, v61, s20, v23
  v_cvt_pk_bf16_f32 v109, v46, v47
  v_mfma_f32_16x16x32_bf16 a[96:99], a[104:107], v[100:103], a[96:99]
  v_exp_f32 v60, v60
  v_exp_f32 v61, v61
  v_fma_f32 v62, v62, s20, v23
  v_mfma_f32_16x16x32_bf16 a[96:99], a[108:111], v[104:107], a[96:99]
  v_exp_f32 v62, v62
  v_cvt_pk_bf16_f32 v110, v60, v61
  v_fma_f32 v63, v63, s20, v23
  v_fma_f32 v64, v64, s20, v20
  v_exp_f32 v63, v63
  v_exp_f32 v64, v64
  v_cvt_pk_bf16_f32 v111, v62, v63
  v_fma_f32 v65, v65, s20, v20
  v_fma_f32 v66, v66, s20, v20
  v_mfma_f32_16x16x32_bf16 a[96:99], a[112:115], v[108:111], a[96:99]
  v_exp_f32 v65, v65
  v_exp_f32 v66, v66
  s_waitcnt lgkmcnt(14)
  v_mfma_f32_16x16x32_bf16 v[128:131], a[160:163], v[96:99], v[128:131]
  ds_read_b64_tr_b16 a[128:129], v4 offset:16384
  v_cvt_pk_bf16_f32 v112, v64, v65
  v_fma_f32 v67, v67, s20, v20
  v_fma_f32 v80, v80, s20, v20
  v_fma_f32 v81, v81, s20, v20
  v_mfma_f32_16x16x32_bf16 v[160:163], a[160:163], v[100:103], v[160:163]
  ds_read_b64_tr_b16 a[130:131], v4 offset:20480
  v_exp_f32 v67, v67
  v_fma_f32 v82, v82, s20, v20
  s_waitcnt lgkmcnt(14)
  v_mfma_f32_16x16x32_bf16 v[132:135], a[164:167], v[96:99], v[132:135]
  ds_read_b64_tr_b16 a[132:133], v5 offset:16384
  v_exp_f32 v80, v80
  v_exp_f32 v81, v81
  v_mfma_f32_16x16x32_bf16 v[164:167], a[164:167], v[100:103], v[164:167]
  ds_read_b64_tr_b16 a[134:135], v5 offset:20480
  v_exp_f32 v82, v82
  v_cvt_pk_bf16_f32 v113, v66, v67
  s_waitcnt lgkmcnt(4)
  v_mfma_f32_16x16x32_bf16 v[136:139], a[168:171], v[96:99], v[136:139]
  ds_read_b64_tr_b16 a[136:137], v6 offset:16384
  v_cvt_pk_bf16_f32 v114, v80, v81
  v_fma_f32 v83, v83, s20, v20
  v_fma_f32 v68, v68, s20, v21
  v_fma_f32 v69, v69, s20, v21
  v_mfma_f32_16x16x32_bf16 v[168:171], a[168:171], v[100:103], v[168:171]
  ds_read_b64_tr_b16 a[138:139], v6 offset:20480
  v_exp_f32 v83, v83
  v_exp_f32 v68, v68
  v_mfma_f32_16x16x32_bf16 v[140:143], a[172:175], v[96:99], v[140:143]
  ds_read_b64_tr_b16 a[140:141], v7 offset:16384
  v_cvt_pk_bf16_f32 v115, v82, v83
  v_exp_f32 v69, v69
  v_fma_f32 v70, v70, s20, v21
  v_mfma_f32_16x16x32_bf16 v[172:175], a[172:175], v[100:103], v[172:175]
  ds_read_b64_tr_b16 a[142:143], v7 offset:20480
  v_exp_f32 v70, v70
  v_cvt_pk_bf16_f32 v116, v68, v69
  v_fma_f32 v71, v71, s20, v21
  v_mfma_f32_16x16x32_bf16 v[144:147], a[176:179], v[96:99], v[144:147]
  ds_read_b64_tr_b16 a[144:145], v8 offset:16384
  v_exp_f32 v71, v71
  v_fma_f32 v84, v84, s20, v21
  v_fma_f32 v85, v85, s20, v21
  v_mfma_f32_16x16x32_bf16 v[176:179], a[176:179], v[100:103], v[176:179]
  ds_read_b64_tr_b16 a[146:147], v8 offset:20480
  v_exp_f32 v84, v84
  v_exp_f32 v85, v85
  v_mfma_f32_16x16x32_bf16 v[148:151], a[180:183], v[96:99], v[148:151]
  ds_read_b64_tr_b16 a[148:149], v9 offset:16384
  v_cvt_pk_bf16_f32 v117, v70, v71
  v_cvt_pk_bf16_f32 v118, v84, v85
  v_fma_f32 v86, v86, s20, v21
  v_fma_f32 v87, v87, s20, v21
  v_mfma_f32_16x16x32_bf16 v[180:183], a[180:183], v[100:103], v[180:183]
  ds_read_b64_tr_b16 a[150:151], v9 offset:20480
  v_exp_f32 v86, v86
  v_exp_f32 v87, v87
  v_mfma_f32_16x16x32_bf16 v[152:155], a[184:187], v[96:99], v[152:155]
  ds_read_b64_tr_b16 a[152:153], v10 offset:16384
  v_cvt_pk_bf16_f32 v119, v86, v87
  v_fma_f32 v72, v72, s20, v22
  v_fma_f32 v73, v73, s20, v22
  v_fma_f32 v74, v74, s20, v22
  v_mfma_f32_16x16x32_bf16 v[184:187], a[184:187], v[100:103], v[184:187]
  ds_read_b64_tr_b16 a[154:155], v10 offset:20480
  v_exp_f32 v72, v72
  v_exp_f32 v73, v73
  v_mfma_f32_16x16x32_bf16 v[156:159], a[188:191], v[96:99], v[156:159]
  ds_read_b64_tr_b16 a[156:157], v11 offset:16384
  v_exp_f32 v74, v74
  v_cvt_pk_bf16_f32 v120, v72, v73
  v_fma_f32 v75, v75, s20, v22
  v_mfma_f32_16x16x32_bf16 v[188:191], a[188:191], v[100:103], v[188:191]
  ds_read_b64_tr_b16 a[158:159], v11 offset:20480
  v_exp_f32 v75, v75
  v_fma_f32 v88, v88, s20, v22
  v_fma_f32 v89, v89, s20, v22
  v_mfma_f32_16x16x32_bf16 v[192:195], a[160:163], v[104:107], v[192:195]
  v_exp_f32 v88, v88
  v_exp_f32 v89, v89
  v_cvt_pk_bf16_f32 v121, v74, v75
  v_mfma_f32_16x16x32_bf16 v[224:227], a[160:163], v[108:111], v[224:227]
  buffer_store_dwordx4 a[240:243], v16, s[12:15], s89 offen offset:0 nt
  v_mfma_f32_16x16x32_bf16 v[196:199], a[164:167], v[104:107], v[196:199]
  v_cvt_pk_bf16_f32 v122, v88, v89
  v_fma_f32 v90, v90, s20, v22
  v_fma_f32 v91, v91, s20, v22
  v_exp_f32 v90, v90
  v_mfma_f32_16x16x32_bf16 v[228:231], a[164:167], v[108:111], v[228:231]
  v_exp_f32 v91, v91
  v_fma_f32 v76, v76, s20, v23
  v_fma_f32 v77, v77, s20, v23
  v_cvt_pk_bf16_f32 v123, v90, v91
  v_mfma_f32_16x16x32_bf16 a[96:99], a[100:103], v[112:115], a[96:99]
  v_exp_f32 v76, v76
  v_mfma_f32_16x16x32_bf16 a[96:99], a[104:107], v[116:119], a[96:99]
  v_exp_f32 v77, v77
  v_mfma_f32_16x16x32_bf16 a[96:99], a[108:111], v[120:123], a[96:99]
  v_fma_f32 v78, v78, s20, v23
  v_cvt_pk_bf16_f32 v124, v76, v77
  v_exp_f32 v78, v78
  v_fma_f32 v79, v79, s20, v23
  v_fma_f32 v92, v92, s20, v23
  v_exp_f32 v79, v79
  v_exp_f32 v92, v92
  v_cvt_pk_bf16_f32 v125, v78, v79
  v_fma_f32 v93, v93, s20, v23
  v_fma_f32 v94, v94, s20, v23
  v_exp_f32 v93, v93
  v_exp_f32 v94, v94
  v_cvt_pk_bf16_f32 v126, v92, v93
  v_fma_f32 v95, v95, s20, v23
  v_xor_b32 v33, 32, v28
  v_exp_f32 v95, v95
  v_xor_b32 v34, 64, v28
  v_xor_b32 v35, 96, v28
  v_cvt_pk_bf16_f32 v127, v94, v95
  v_xor_b32 v36, 128, v28
  v_xor_b32 v37, 160, v28
  v_mfma_f32_16x16x32_bf16 a[96:99], a[112:115], v[124:127], a[96:99]
  v_xor_b32 v38, 192, v28
  v_xor_b32 v39, 224, v28
  v_mfma_f32_16x16x32_bf16 v[200:203], a[168:171], v[104:107], v[200:203]
  buffer_store_dwordx4 a[244:247], v17, s[12:15], s89 offen offset:1024 nt
  v_mfma_f32_16x16x32_bf16 v[232:235], a[168:171], v[108:111], v[232:235]
  v_mov_b32 v21, s92
  v_mfma_f32_16x16x32_bf16 v[204:207], a[172:175], v[104:107], v[204:207]
  v_mfma_f32_16x16x32_bf16 v[236:239], a[172:175], v[108:111], v[236:239]
  buffer_store_dwordx4 a[248:251], v18, s[12:15], s89 offen offset:2048 nt
  v_mfma_f32_16x16x32_bf16 v[208:211], a[176:179], v[104:107], v[208:211]
  v_accvgpr_read_b32 v30, a96
  v_accvgpr_read_b32 v31, a97
  v_mfma_f32_16x16x32_bf16 v[240:243], a[176:179], v[108:111], v[240:243]
  v_rcp_f32 v24, v30
  v_mfma_f32_16x16x32_bf16 v[212:215], a[180:183], v[104:107], v[212:215]
  buffer_store_dwordx4 a[252:255], v19, s[12:15], s89 offen offset:3072 nt
  v_mfma_f32_16x16x32_bf16 v[244:247], a[180:183], v[108:111], v[244:247]
  v_rcp_f32 v25, v31
  v_mfma_f32_16x16x32_bf16 v[216:219], a[184:187], v[104:107], v[216:219]
  v_cmp_nle_f32 s[30:31], v30, s25
  v_cmp_nle_f32 s[44:45], v31, s25
  v_mfma_f32_16x16x32_bf16 v[248:251], a[184:187], v[108:111], v[248:251]
  v_accvgpr_read_b32 v30, a98
  s_or_b64 s[30:31], s[30:31], s[44:45]
  v_mfma_f32_16x16x32_bf16 v[220:223], a[188:191], v[104:107], v[220:223]
  v_rcp_f32 v26, v30
  v_mfma_f32_16x16x32_bf16 v[252:255], a[188:191], v[108:111], v[252:255]
  s_add_u32 s12, s12, 0xf80000
  s_addc_u32 s13, s13, 0
  s_mov_b32 s14, s91
  v_cmp_nle_f32 s[44:45], v30, s25
  v_accvgpr_read_b32 v31, a99
  s_nop 0
  s_or_b64 s[30:31], s[30:31], s[44:45]
  v_rcp_f32 v27, v31
  v_cmp_nle_f32 s[44:45], v31, s25
  s_nop 1
  s_or_b64 s[30:31], s[30:31], s[44:45]
  s_cmp_lg_u64 s[30:31], 0
  s_cselect_b32 s27, s46, 0
  s_or_b32 s24, s24, s27
  v_mov_b32 v20, s24
  ds_write_b32 v21, v20
  s_waitcnt lgkmcnt(1)
  v_mfma_f32_16x16x32_bf16 v[128:131], a[128:131], v[112:115], v[128:131]
  v_mfma_f32_16x16x32_bf16 v[132:135], a[132:135], v[112:115], v[132:135]
  v_mfma_f32_16x16x32_bf16 v[136:139], a[136:139], v[112:115], v[136:139]
  v_mfma_f32_16x16x32_bf16 v[140:143], a[140:143], v[112:115], v[140:143]
  v_mfma_f32_16x16x32_bf16 v[144:147], a[144:147], v[112:115], v[144:147]
  v_mfma_f32_16x16x32_bf16 v[148:151], a[148:151], v[112:115], v[148:151]
  v_mfma_f32_16x16x32_bf16 v[152:155], a[152:155], v[112:115], v[152:155]
  s_nop 1
  v_mul_f32 v128, v128, v24
  v_mul_f32 v129, v129, v24
  v_mul_f32 v130, v130, v24
  v_mul_f32 v131, v131, v24
  v_cvt_pk_bf16_f32 v128, v128, v129
  v_cvt_pk_bf16_f32 v129, v130, v131
  v_mfma_f32_16x16x32_bf16 v[156:159], a[156:159], v[112:115], v[156:159]
  ds_write_b64 v28, v[128:129] offset:0
  v_mul_f32 v132, v132, v24
  v_mul_f32 v133, v133, v24
  v_mul_f32 v134, v134, v24
  v_mul_f32 v135, v135, v24
  v_cvt_pk_bf16_f32 v132, v132, v133
  v_cvt_pk_bf16_f32 v133, v134, v135
  v_mfma_f32_16x16x32_bf16 v[160:163], a[128:131], v[116:119], v[160:163]
  ds_write_b64 v33, v[132:133] offset:0
  v_mul_f32 v136, v136, v24
  v_mul_f32 v137, v137, v24
  v_mul_f32 v138, v138, v24
  v_mul_f32 v139, v139, v24
  v_cvt_pk_bf16_f32 v136, v136, v137
  v_cvt_pk_bf16_f32 v137, v138, v139
  v_mfma_f32_16x16x32_bf16 v[164:167], a[132:135], v[116:119], v[164:167]
  ds_write_b64 v34, v[136:137] offset:0
  v_mul_f32 v140, v140, v24
  v_mul_f32 v141, v141, v24
  v_mul_f32 v142, v142, v24
  v_mul_f32 v143, v143, v24
  v_cvt_pk_bf16_f32 v140, v140, v141
  v_cvt_pk_bf16_f32 v141, v142, v143
  v_mfma_f32_16x16x32_bf16 v[168:171], a[136:139], v[116:119], v[168:171]
  ds_write_b64 v35, v[140:141] offset:0
  v_mul_f32 v144, v144, v24
  v_mul_f32 v145, v145, v24
  v_mul_f32 v146, v146, v24
  v_mul_f32 v147, v147, v24
  v_cvt_pk_bf16_f32 v144, v144, v145
  v_cvt_pk_bf16_f32 v145, v146, v147
  v_mfma_f32_16x16x32_bf16 v[172:175], a[140:143], v[116:119], v[172:175]
  ds_write_b64 v36, v[144:145] offset:0
  v_mul_f32 v148, v148, v24
  v_mul_f32 v149, v149, v24
  v_mul_f32 v150, v150, v24
  v_mul_f32 v151, v151, v24
  v_cvt_pk_bf16_f32 v148, v148, v149
  v_cvt_pk_bf16_f32 v149, v150, v151
  v_mfma_f32_16x16x32_bf16 v[176:179], a[144:147], v[116:119], v[176:179]
  ds_write_b64 v37, v[148:149] offset:0
  v_mul_f32 v152, v152, v24
  v_mul_f32 v153, v153, v24
  v_mul_f32 v154, v154, v24
  v_mul_f32 v155, v155, v24
  v_cvt_pk_bf16_f32 v152, v152, v153
  v_cvt_pk_bf16_f32 v153, v154, v155
  v_mfma_f32_16x16x32_bf16 v[180:183], a[148:151], v[116:119], v[180:183]
  ds_write_b64 v38, v[152:153] offset:0
  v_mul_f32 v156, v156, v24
  v_mul_f32 v157, v157, v24
  v_mul_f32 v158, v158, v24
  v_mul_f32 v159, v159, v24
  v_cvt_pk_bf16_f32 v156, v156, v157
  v_cvt_pk_bf16_f32 v157, v158, v159
  v_mfma_f32_16x16x32_bf16 v[184:187], a[152:155], v[116:119], v[184:187]
  ds_write_b64 v39, v[156:157] offset:0
  v_mul_f32 v160, v160, v25
  v_mul_f32 v161, v161, v25
  v_mul_f32 v162, v162, v25
  v_mul_f32 v163, v163, v25
  v_cvt_pk_bf16_f32 v160, v160, v161
  v_cvt_pk_bf16_f32 v161, v162, v163
  v_mfma_f32_16x16x32_bf16 v[188:191], a[156:159], v[116:119], v[188:191]
  ds_write_b64 v28, v[160:161] offset:4096
  ds_read_b128 a[192:195], v29 offset:0
  v_mul_f32 v164, v164, v25
  v_mul_f32 v165, v165, v25
  v_mul_f32 v166, v166, v25
  v_mul_f32 v167, v167, v25
  v_cvt_pk_bf16_f32 v164, v164, v165
  v_cvt_pk_bf16_f32 v165, v166, v167
  v_mfma_f32_16x16x32_bf16 v[192:195], a[128:131], v[120:123], v[192:195]
  ds_write_b64 v33, v[164:165] offset:4096
  ds_read_b128 a[196:199], v29 offset:1024
  v_mul_f32 v168, v168, v25
  v_mul_f32 v169, v169, v25
  v_mul_f32 v170, v170, v25
  v_mul_f32 v171, v171, v25
  v_cvt_pk_bf16_f32 v168, v168, v169
  v_cvt_pk_bf16_f32 v169, v170, v171
  v_mfma_f32_16x16x32_bf16 v[196:199], a[132:135], v[120:123], v[196:199]
  ds_write_b64 v34, v[168:169] offset:4096
  ds_read_b128 a[200:203], v29 offset:2048
  v_mul_f32 v172, v172, v25
  v_mul_f32 v173, v173, v25
  v_mul_f32 v174, v174, v25
  v_mul_f32 v175, v175, v25
  v_cvt_pk_bf16_f32 v172, v172, v173
  v_cvt_pk_bf16_f32 v173, v174, v175
  v_mfma_f32_16x16x32_bf16 v[200:203], a[136:139], v[120:123], v[200:203]
  ds_write_b64 v35, v[172:173] offset:4096
  ds_read_b128 a[204:207], v29 offset:3072
  v_mul_f32 v176, v176, v25
  v_mul_f32 v177, v177, v25
  v_mul_f32 v178, v178, v25
  v_mul_f32 v179, v179, v25
  v_cvt_pk_bf16_f32 v176, v176, v177
  v_cvt_pk_bf16_f32 v177, v178, v179
  v_mfma_f32_16x16x32_bf16 v[204:207], a[140:143], v[120:123], v[204:207]
  ds_write_b64 v36, v[176:177] offset:4096
  v_mul_f32 v180, v180, v25
  v_mul_f32 v181, v181, v25
  v_mul_f32 v182, v182, v25
  v_mul_f32 v183, v183, v25
  v_cvt_pk_bf16_f32 v180, v180, v181
  v_cvt_pk_bf16_f32 v181, v182, v183
  v_mfma_f32_16x16x32_bf16 v[208:211], a[144:147], v[120:123], v[208:211]
  ds_write_b64 v37, v[180:181] offset:4096
  v_mul_f32 v184, v184, v25
  v_mul_f32 v185, v185, v25
  v_mul_f32 v186, v186, v25
  v_mul_f32 v187, v187, v25
  v_cvt_pk_bf16_f32 v184, v184, v185
  v_cvt_pk_bf16_f32 v185, v186, v187
  s_waitcnt lgkmcnt(15)
  s_barrier
  v_mov_b32 v40, 0xa000
  ds_read_b128 v[44:47], v40
  v_mfma_f32_16x16x32_bf16 v[212:215], a[148:151], v[120:123], v[212:215]
  ds_write_b64 v38, v[184:185] offset:4096
  s_waitcnt lgkmcnt(4)
  buffer_store_dwordx4 a[192:195], v16, s[12:15], 0 offen offset:0 nt
  v_mul_f32 v188, v188, v25
  v_mul_f32 v189, v189, v25
  v_mul_f32 v190, v190, v25
  v_mul_f32 v191, v191, v25
  v_cvt_pk_bf16_f32 v188, v188, v189
  v_cvt_pk_bf16_f32 v189, v190, v191
  v_mfma_f32_16x16x32_bf16 v[216:219], a[152:155], v[120:123], v[216:219]
  ds_write_b64 v39, v[188:189] offset:4096
  v_mul_f32 v192, v192, v26
  v_mul_f32 v193, v193, v26
  v_mul_f32 v194, v194, v26
  v_mul_f32 v195, v195, v26
  v_cvt_pk_bf16_f32 v192, v192, v193
  v_cvt_pk_bf16_f32 v193, v194, v195
  v_mfma_f32_16x16x32_bf16 v[220:223], a[156:159], v[120:123], v[220:223]
  ds_write_b64 v28, v[192:193] offset:8192
  buffer_store_dwordx4 a[196:199], v17, s[12:15], 0 offen offset:1024 nt
  ds_read_b128 a[208:211], v29 offset:4096
  v_mul_f32 v196, v196, v26
  v_mul_f32 v197, v197, v26
  v_mul_f32 v198, v198, v26
  v_mul_f32 v199, v199, v26
  v_cvt_pk_bf16_f32 v196, v196, v197
  v_cvt_pk_bf16_f32 v197, v198, v199
  v_mfma_f32_16x16x32_bf16 v[224:227], a[128:131], v[124:127], v[224:227]
  ds_write_b64 v33, v[196:197] offset:8192
  ds_read_b128 a[212:215], v29 offset:5120
  v_mul_f32 v200, v200, v26
  v_mul_f32 v201, v201, v26
  v_mul_f32 v202, v202, v26
  v_mul_f32 v203, v203, v26
  v_cvt_pk_bf16_f32 v200, v200, v201
  v_cvt_pk_bf16_f32 v201, v202, v203
  v_mfma_f32_16x16x32_bf16 v[228:231], a[132:135], v[124:127], v[228:231]
  ds_write_b64 v34, v[200:201] offset:8192
  buffer_store_dwordx4 a[200:203], v18, s[12:15], 0 offen offset:2048 nt
  ds_read_b128 a[216:219], v29 offset:6144
  v_mul_f32 v204, v204, v26
  v_mul_f32 v205, v205, v26
  v_mul_f32 v206, v206, v26
  v_mul_f32 v207, v207, v26
  v_cvt_pk_bf16_f32 v204, v204, v205
  v_cvt_pk_bf16_f32 v205, v206, v207
  v_mfma_f32_16x16x32_bf16 v[232:235], a[136:139], v[124:127], v[232:235]
  ds_write_b64 v35, v[204:205] offset:8192
  ds_read_b128 a[220:223], v29 offset:7168
  v_mul_f32 v208, v208, v26
  v_mul_f32 v209, v209, v26
  v_mul_f32 v210, v210, v26
  v_mul_f32 v211, v211, v26
  v_cvt_pk_bf16_f32 v208, v208, v209
  v_cvt_pk_bf16_f32 v209, v210, v211
  v_mfma_f32_16x16x32_bf16 v[236:239], a[140:143], v[124:127], v[236:239]
  ds_write_b64 v36, v[208:209] offset:8192
  buffer_store_dwordx4 a[204:207], v19, s[12:15], 0 offen offset:3072 nt
  v_mul_f32 v212, v212, v26
  v_mul_f32 v213, v213, v26
  v_mul_f32 v214, v214, v26
  v_mul_f32 v215, v215, v26
  v_cvt_pk_bf16_f32 v212, v212, v213
  v_cvt_pk_bf16_f32 v213, v214, v215
  v_mfma_f32_16x16x32_bf16 v[240:243], a[144:147], v[124:127], v[240:243]
  ds_write_b64 v37, v[212:213] offset:8192
  v_mul_f32 v216, v216, v26
  v_mul_f32 v217, v217, v26
  v_mul_f32 v218, v218, v26
  v_mul_f32 v219, v219, v26
  v_cvt_pk_bf16_f32 v216, v216, v217
  v_cvt_pk_bf16_f32 v217, v218, v219
  v_mfma_f32_16x16x32_bf16 v[244:247], a[148:151], v[124:127], v[244:247]
  ds_write_b64 v38, v[216:217] offset:8192
  s_waitcnt lgkmcnt(3)
  buffer_store_dwordx4 a[208:211], v16, s[12:15], s87 offen offset:0 nt
  v_mul_f32 v220, v220, v26
  v_mul_f32 v221, v221, v26
  v_mul_f32 v222, v222, v26
  v_mul_f32 v223, v223, v26
  v_cvt_pk_bf16_f32 v220, v220, v221
  v_cvt_pk_bf16_f32 v221, v222, v223
  v_mfma_f32_16x16x32_bf16 v[248:251], a[152:155], v[124:127], v[248:251]
  ds_write_b64 v39, v[220:221] offset:8192
  v_mul_f32 v224, v224, v27
  v_mul_f32 v225, v225, v27
  v_mul_f32 v226, v226, v27
  v_mul_f32 v227, v227, v27
  v_cvt_pk_bf16_f32 v224, v224, v225
  v_cvt_pk_bf16_f32 v225, v226, v227
  v_mfma_f32_16x16x32_bf16 v[252:255], a[156:159], v[124:127], v[252:255]
  ds_write_b64 v28, v[224:225] offset:12288
  buffer_store_dwordx4 a[212:215], v17, s[12:15], s87 offen offset:1024 nt
  ds_read_b128 a[224:227], v29 offset:8192
  v_mul_f32 v228, v228, v27
  v_mul_f32 v229, v229, v27
  v_mul_f32 v230, v230, v27
  v_mul_f32 v231, v231, v27
  v_cvt_pk_bf16_f32 v228, v228, v229
  v_cvt_pk_bf16_f32 v229, v230, v231
  ds_write_b64 v33, v[228:229] offset:12288
  ds_read_b128 a[228:231], v29 offset:9216
  v_mul_f32 v232, v232, v27
  v_mul_f32 v233, v233, v27
  v_mul_f32 v234, v234, v27
  v_mul_f32 v235, v235, v27
  v_cvt_pk_bf16_f32 v232, v232, v233
  v_cvt_pk_bf16_f32 v233, v234, v235
  ds_write_b64 v34, v[232:233] offset:12288
  buffer_store_dwordx4 a[216:219], v18, s[12:15], s87 offen offset:2048 nt
  ds_read_b128 a[232:235], v29 offset:10240
  v_mul_f32 v236, v236, v27
  v_mul_f32 v237, v237, v27
  v_mul_f32 v238, v238, v27
  v_mul_f32 v239, v239, v27
  v_cvt_pk_bf16_f32 v236, v236, v237
  v_cvt_pk_bf16_f32 v237, v238, v239
  ds_write_b64 v35, v[236:237] offset:12288
  ds_read_b128 a[236:239], v29 offset:11264
  v_mul_f32 v240, v240, v27
  v_mul_f32 v241, v241, v27
  v_mul_f32 v242, v242, v27
  v_mul_f32 v243, v243, v27
  v_cvt_pk_bf16_f32 v240, v240, v241
  v_cvt_pk_bf16_f32 v241, v242, v243
  ds_write_b64 v36, v[240:241] offset:12288
  buffer_store_dwordx4 a[220:223], v19, s[12:15], s87 offen offset:3072 nt
  v_mul_f32 v244, v244, v27
  v_mul_f32 v245, v245, v27
  v_mul_f32 v246, v246, v27
  v_mul_f32 v247, v247, v27
  v_cvt_pk_bf16_f32 v244, v244, v245
  v_cvt_pk_bf16_f32 v245, v246, v247
  ds_write_b64 v37, v[244:245] offset:12288
  v_mul_f32 v248, v248, v27
  v_mul_f32 v249, v249, v27
  v_mul_f32 v250, v250, v27
  v_mul_f32 v251, v251, v27
  v_cvt_pk_bf16_f32 v248, v248, v249
  v_cvt_pk_bf16_f32 v249, v250, v251
  ds_write_b64 v38, v[248:249] offset:12288
  s_waitcnt lgkmcnt(3)
  buffer_store_dwordx4 a[224:227], v16, s[12:15], s88 offen offset:0 nt
  v_mul_f32 v252, v252, v27
  v_mul_f32 v253, v253, v27
  v_mul_f32 v254, v254, v27
  v_mul_f32 v255, v255, v27
  v_cvt_pk_bf16_f32 v252, v252, v253
  v_cvt_pk_bf16_f32 v253, v254, v255
  ds_write_b64 v39, v[252:253] offset:12288
  buffer_store_dwordx4 a[228:231], v17, s[12:15], s88 offen offset:1024 nt
  ds_read_b128 a[240:243], v29 offset:12288
  ds_read_b128 a[244:247], v29 offset:13312
  buffer_store_dwordx4 a[232:235], v18, s[12:15], s88 offen offset:2048 nt
  ds_read_b128 a[248:251], v29 offset:14336
  ds_read_b128 a[252:255], v29 offset:15360
  buffer_store_dwordx4 a[236:239], v19, s[12:15], s88 offen offset:3072 nt
  s_waitcnt lgkmcnt(0)
  buffer_store_dwordx4 a[240:243], v16, s[12:15], s89 offen offset:0 nt
  buffer_store_dwordx4 a[244:247], v17, s[12:15], s89 offen offset:1024 nt
  buffer_store_dwordx4 a[248:251], v18, s[12:15], s89 offen offset:2048 nt
  buffer_store_dwordx4 a[252:255], v19, s[12:15], s89 offen offset:3072 nt
  s_waitcnt lgkmcnt(0)
  v_or_b32 v44, v44, v45
  v_or_b32 v46, v46, v47
  v_or_b32 v44, v44, v46
  s_nop 1
  v_readfirstlane_b32 s24, v44
  s_nop 3
  s_cmp_eq_u32 s24, 0
  s_cbranch_scc1 L_fin
L_slow:
  s_mov_b32 s21, 0
L_sb:
  s_lshr_b32 s27, s24, s21
  s_and_b32 s27, s27, 1
  s_cmp_eq_u32 s27, 0
  s_cbranch_scc1 L_sb_next
  s_lshl_b32 s27, s21, 7
  s_add_u32 s27, s27, s40
  s_mul_i32 s28, s27, 0x1f000
  s_add_u32 s28, s28, s93
  s_add_u32 s4, s32, s28
  s_addc_u32 s5, s33, 0
  s_mov_b32 s6, s91
  s_add_u32 s12, s38, s28
  s_addc_u32 s13, s39, 0
  s_mov_b32 s14, s91
  s_cmp_lt_u32 s26, 2
  s_cselect_b32 s8, s34, s36
  s_cselect_b32 s9, s35, s37
  s_lshl_b32 s27, s27, 17
  s_add_u32 s8, s8, s27
  s_addc_u32 s9, s9, 0
  s_mov_b32 s10, 0x20000
  s_waitcnt vmcnt(0) lgkmcnt(0)
  s_barrier
  s_add_u32 m0, s90, 0x0
  s_nop 0
  buffer_load_dwordx4 v16, s[4:7], 0 offen offset:0 nt lds
  buffer_load_dwordx4 v17, s[4:7], 0 offen offset:1024 nt lds
  buffer_load_dwordx4 v18, s[4:7], 0 offen offset:2048 nt lds
  buffer_load_dwordx4 v19, s[4:7], 0 offen offset:3072 nt lds
  s_add_u32 m0, s90, 0x1000
  s_nop 0
  buffer_load_dwordx4 v16, s[4:7], s87 offen offset:0 nt lds
  buffer_load_dwordx4 v17, s[4:7], s87 offen offset:1024 nt lds
  buffer_load_dwordx4 v18, s[4:7], s87 offen offset:2048 nt lds
  buffer_load_dwordx4 v19, s[4:7], s87 offen offset:3072 nt lds
  s_add_u32 m0, s90, 0x2000
  s_nop 0
  buffer_load_dwordx4 v16, s[4:7], s88 offen offset:0 nt lds
  buffer_load_dwordx4 v17, s[4:7], s88 offen offset:1024 nt lds
  buffer_load_dwordx4 v18, s[4:7], s88 offen offset:2048 nt lds
  buffer_load_dwordx4 v19, s[4:7], s88 offen offset:3072 nt lds
  s_add_u32 m0, s90, 0x3000
  s_nop 0
  buffer_load_dwordx4 v16, s[4:7], s89 offen offset:0 nt lds
  buffer_load_dwordx4 v17, s[4:7], s89 offen offset:1024 nt lds
  buffer_load_dwordx4 v18, s[4:7], s89 offen offset:2048 nt lds
  buffer_load_dwordx4 v19, s[4:7], s89 offen offset:3072 nt lds
  s_waitcnt vmcnt(0)
  v_add_u32 v30, s90, v0
  ds_read_b128 a[0:3], v30 offset:0
  ds_read_b128 a[16:19], v30 offset:4096
  ds_read_b128 a[32:35], v30 offset:8192
  ds_read_b128 a[48:51], v30 offset:12288
  v_add_u32 v31, s90, v1
  ds_read_b128 a[4:7], v31 offset:0
  ds_read_b128 a[20:23], v31 offset:4096
  ds_read_b128 a[36:39], v31 offset:8192
  ds_read_b128 a[52:55], v31 offset:12288
  v_add_u32 v30, s90, v2
  ds_read_b128 a[8:11], v30 offset:0
  ds_read_b128 a[24:27], v30 offset:4096
  ds_read_b128 a[40:43], v30 offset:8192
  ds_read_b128 a[56:59], v30 offset:12288
  v_add_u32 v31, s90, v3
  ds_read_b128 a[12:15], v31 offset:0
  ds_read_b128 a[28:31], v31 offset:4096
  ds_read_b128 a[44:47], v31 offset:8192
  ds_read_b128 a[60:63], v31 offset:12288
  v_mov_b32 v128, 0
  v_mov_b32 v129, 0
  v_mov_b32 v130, 0
  v_mov_b32 v131, 0
  v_mov_b32 v132, 0
  v_mov_b32 v133, 0
  v_mov_b32 v134, 0
  v_mov_b32 v135, 0
  v_mov_b32 v136, 0
  v_mov_b32 v137, 0
  v_mov_b32 v138, 0
  v_mov_b32 v139, 0
  v_mov_b32 v140, 0
  v_mov_b32 v141, 0
  v_mov_b32 v142, 0
  v_mov_b32 v143, 0
  v_mov_b32 v144, 0
  v_mov_b32 v145, 0
  v_mov_b32 v146, 0
  v_mov_b32 v147, 0
  v_mov_b32 v148, 0
  v_mov_b32 v149, 0
  v_mov_b32 v150, 0
  v_mov_b32 v151, 0
  v_mov_b32 v152, 0
  v_mov_b32 v153, 0
  v_mov_b32 v154, 0
  v_mov_b32 v155, 0
  v_mov_b32 v156, 0
  v_mov_b32 v157, 0
  v_mov_b32 v158, 0
  v_mov_b32 v159, 0
  v_mov_b32 v160, 0
  v_mov_b32 v161, 0
  v_mov_b32 v162, 0
  v_mov_b32 v163, 0
  v_mov_b32 v164, 0
  v_mov_b32 v165, 0
  v_mov_b32 v166, 0
  v_mov_b32 v167, 0
  v_mov_b32 v168, 0
  v_mov_b32 v169, 0
  v_mov_b32 v170, 0
  v_mov_b32 v171, 0
  v_mov_b32 v172, 0
  v_mov_b32 v173, 0
  v_mov_b32 v174, 0
  v_mov_b32 v175, 0
  v_mov_b32 v176, 0
  v_mov_b32 v177, 0
  v_mov_b32 v178, 0
  v_mov_b32 v179, 0
  v_mov_b32 v180, 0
  v_mov_b32 v181, 0
  v_mov_b32 v182, 0
  v_mov_b32 v183, 0
  v_mov_b32 v184, 0
  v_mov_b32 v185, 0
  v_mov_b32 v186, 0
  v_mov_b32 v187, 0
  v_mov_b32 v188, 0
  v_mov_b32 v189, 0
  v_mov_b32 v190, 0
  v_mov_b32 v191, 0
  v_mov_b32 v192, 0
  v_mov_b32 v193, 0
  v_mov_b32 v194, 0
  v_mov_b32 v195, 0
  v_mov_b32 v196, 0
  v_mov_b32 v197, 0
  v_mov_b32 v198, 0
  v_mov_b32 v199, 0
  v_mov_b32 v200, 0
  v_mov_b32 v201, 0
  v_mov_b32 v202, 0
  v_mov_b32 v203, 0
  v_mov_b32 v204, 0
  v_mov_b32 v205, 0
  v_mov_b32 v206, 0
  v_mov_b32 v207, 0
  v_mov_b32 v208, 0
  v_mov_b32 v209, 0
  v_mov_b32 v210, 0
  v_mov_b32 v211, 0
  v_mov_b32 v212, 0
  v_mov_b32 v213, 0
  v_mov_b32 v214, 0
  v_mov_b32 v215, 0
  v_mov_b32 v216, 0
  v_mov_b32 v217, 0
  v_mov_b32 v218, 0
  v_mov_b32 v219, 0
  v_mov_b32 v220, 0
  v_mov_b32 v221, 0
  v_mov_b32 v222, 0
  v_mov_b32 v223, 0
  v_mov_b32 v224, 0
  v_mov_b32 v225, 0
  v_mov_b32 v226, 0
  v_mov_b32 v227, 0
  v_mov_b32 v228, 0
  v_mov_b32 v229, 0
  v_mov_b32 v230, 0
  v_mov_b32 v231, 0
  v_mov_b32 v232, 0
  v_mov_b32 v233, 0
  v_mov_b32 v234, 0
  v_mov_b32 v235, 0
  v_mov_b32 v236, 0
  v_mov_b32 v237, 0
  v_mov_b32 v238, 0
  v_mov_b32 v239, 0
  v_mov_b32 v240, 0
  v_mov_b32 v241, 0
  v_mov_b32 v242, 0
  v_mov_b32 v243, 0
  v_mov_b32 v244, 0
  v_mov_b32 v245, 0
  v_mov_b32 v246, 0
  v_mov_b32 v247, 0
  v_mov_b32 v248, 0
  v_mov_b32 v249, 0
  v_mov_b32 v250, 0
  v_mov_b32 v251, 0
  v_mov_b32 v252, 0
  v_mov_b32 v253, 0
  v_mov_b32 v254, 0
  v_mov_b32 v255, 0
  v_mov_b32 v80, 0
  v_mov_b32 v64, 0xff800000
  v_mov_b32 v81, 0
  v_mov_b32 v65, 0xff800000
  v_mov_b32 v82, 0
  v_mov_b32 v66, 0xff800000
  v_mov_b32 v83, 0
  v_mov_b32 v67, 0xff800000
  s_mov_b32 s16, 0
L_st:
  s_mov_b32 m0, s19
  s_nop 0
  buffer_load_dwordx4 v12, s[8:11], s16 offen offset:0 lds
  buffer_load_dwordx4 v13, s[8:11], s16 offen offset:1024 lds
  buffer_load_dwordx4 v14, s[8:11], s16 offen offset:2048 lds
  buffer_load_dwordx4 v15, s[8:11], s16 offen offset:3072 lds
  s_waitcnt vmcnt(0)
  s_barrier
  ds_read_b128 a[128:131], v0 offset:0
  ds_read_b128 a[132:135], v1 offset:0
  ds_read_b128 a[136:139], v2 offset:0
  ds_read_b128 a[140:143], v3 offset:0
  ds_read_b128 a[144:147], v0 offset:4096
  ds_read_b128 a[148:151], v1 offset:4096
  ds_read_b128 a[152:155], v2 offset:4096
  ds_read_b128 a[156:159], v3 offset:4096
  ds_read_b64_tr_b16 a[160:161], v4 offset:0
  ds_read_b64_tr_b16 a[162:163], v4 offset:4096
  ds_read_b64_tr_b16 a[164:165], v5 offset:0
  ds_read_b64_tr_b16 a[166:167], v5 offset:4096
  ds_read_b64_tr_b16 a[168:169], v6 offset:0
  ds_read_b64_tr_b16 a[170:171], v6 offset:4096
  ds_read_b64_tr_b16 a[172:173], v7 offset:0
  ds_read_b64_tr_b16 a[174:175], v7 offset:4096
  ds_read_b64_tr_b16 a[176:177], v8 offset:0
  ds_read_b64_tr_b16 a[178:179], v8 offset:4096
  ds_read_b64_tr_b16 a[180:181], v9 offset:0
  ds_read_b64_tr_b16 a[182:183], v9 offset:4096
  ds_read_b64_tr_b16 a[184:185], v10 offset:0
  ds_read_b64_tr_b16 a[186:187], v10 offset:4096
  ds_read_b64_tr_b16 a[188:189], v11 offset:0
  ds_read_b64_tr_b16 a[190:191], v11 offset:4096
  s_waitcnt lgkmcnt(0)
  v_mfma_f32_16x16x32_bf16 v[32:35], a[128:131], a[0:3], 0
  v_mfma_f32_16x16x32_bf16 v[32:35], a[132:135], a[4:7], v[32:35]
  v_mfma_f32_16x16x32_bf16 v[32:35], a[136:139], a[8:11], v[32:35]
  v_mfma_f32_16x16x32_bf16 v[32:35], a[140:143], a[12:15], v[32:35]
  v_mfma_f32_16x16x32_bf16 v[48:51], a[144:147], a[0:3], 0
  v_mfma_f32_16x16x32_bf16 v[48:51], a[148:151], a[4:7], v[48:51]
  v_mfma_f32_16x16x32_bf16 v[48:51], a[152:155], a[8:11], v[48:51]
  v_mfma_f32_16x16x32_bf16 v[48:51], a[156:159], a[12:15], v[48:51]
  v_mfma_f32_16x16x32_bf16 v[36:39], a[128:131], a[16:19], 0
  v_mfma_f32_16x16x32_bf16 v[36:39], a[132:135], a[20:23], v[36:39]
  v_mfma_f32_16x16x32_bf16 v[36:39], a[136:139], a[24:27], v[36:39]
  v_mfma_f32_16x16x32_bf16 v[36:39], a[140:143], a[28:31], v[36:39]
  v_mfma_f32_16x16x32_bf16 v[52:55], a[144:147], a[16:19], 0
  v_mfma_f32_16x16x32_bf16 v[52:55], a[148:151], a[20:23], v[52:55]
  v_mfma_f32_16x16x32_bf16 v[52:55], a[152:155], a[24:27], v[52:55]
  v_mfma_f32_16x16x32_bf16 v[52:55], a[156:159], a[28:31], v[52:55]
  v_mfma_f32_16x16x32_bf16 v[40:43], a[128:131], a[32:35], 0
  v_mfma_f32_16x16x32_bf16 v[40:43], a[132:135], a[36:39], v[40:43]
  v_mfma_f32_16x16x32_bf16 v[40:43], a[136:139], a[40:43], v[40:43]
  v_mfma_f32_16x16x32_bf16 v[40:43], a[140:143], a[44:47], v[40:43]
  v_mfma_f32_16x16x32_bf16 v[56:59], a[144:147], a[32:35], 0
  v_mfma_f32_16x16x32_bf16 v[56:59], a[148:151], a[36:39], v[56:59]
  v_mfma_f32_16x16x32_bf16 v[56:59], a[152:155], a[40:43], v[56:59]
  v_mfma_f32_16x16x32_bf16 v[56:59], a[156:159], a[44:47], v[56:59]
  v_mfma_f32_16x16x32_bf16 v[44:47], a[128:131], a[48:51], 0
  v_mfma_f32_16x16x32_bf16 v[44:47], a[132:135], a[52:55], v[44:47]
  v_mfma_f32_16x16x32_bf16 v[44:47], a[136:139], a[56:59], v[44:47]
  v_mfma_f32_16x16x32_bf16 v[44:47], a[140:143], a[60:63], v[44:47]
  v_mfma_f32_16x16x32_bf16 v[60:63], a[144:147], a[48:51], 0
  v_mfma_f32_16x16x32_bf16 v[60:63], a[148:151], a[52:55], v[60:63]
  v_mfma_f32_16x16x32_bf16 v[60:63], a[152:155], a[56:59], v[60:63]
  v_mfma_f32_16x16x32_bf16 v[60:63], a[156:159], a[60:63], v[60:63]
  v_max3_f32 v72, v32, v33, v34
  v_max3_f32 v72, v72, v35, v48
  v_max3_f32 v72, v72, v49, v50
  v_max3_f32 v72, v72, v51, v64
  v_mov_b32 v76, v72
  s_nop 1
  v_permlane16_swap_b32 v76, v72
  v_max_f32 v72, v72, v76
  v_mov_b32 v76, v72
  s_nop 1
  v_permlane32_swap_b32 v76, v72
  v_max_f32 v72, v72, v76
  v_sub_f32 v76, v64, v72
  v_mul_f32 v76, s20, v76
  v_exp_f32 v68, v76
  v_mov_b32 v64, v72
  v_mul_f32 v20, s43, v72
  v_mul_f32 v80, v80, v68
  v_fma_f32 v32, v32, s20, v20
  v_fma_f32 v33, v33, s20, v20
  v_fma_f32 v34, v34, s20, v20
  v_fma_f32 v35, v35, s20, v20
  v_fma_f32 v48, v48, s20, v20
  v_fma_f32 v49, v49, s20, v20
  v_fma_f32 v50, v50, s20, v20
  v_fma_f32 v51, v51, s20, v20
  v_exp_f32 v32, v32
  v_exp_f32 v33, v33
  v_exp_f32 v34, v34
  v_exp_f32 v35, v35
  v_exp_f32 v48, v48
  v_exp_f32 v49, v49
  v_exp_f32 v50, v50
  v_exp_f32 v51, v51
  v_add_f32 v80, v80, v32
  v_add_f32 v80, v80, v33
  v_add_f32 v80, v80, v34
  v_add_f32 v80, v80, v35
  v_add_f32 v80, v80, v48
  v_add_f32 v80, v80, v49
  v_add_f32 v80, v80, v50
  v_add_f32 v80, v80, v51
  v_cvt_pk_bf16_f32 v96, v32, v33
  v_cvt_pk_bf16_f32 v97, v34, v35
  v_cvt_pk_bf16_f32 v98, v48, v49
  v_cvt_pk_bf16_f32 v99, v50, v51
  v_mul_f32 v128, v128, v68
  v_mul_f32 v129, v129, v68
  v_mul_f32 v130, v130, v68
  v_mul_f32 v131, v131, v68
  v_mul_f32 v132, v132, v68
  v_mul_f32 v133, v133, v68
  v_mul_f32 v134, v134, v68
  v_mul_f32 v135, v135, v68
  v_mul_f32 v136, v136, v68
  v_mul_f32 v137, v137, v68
  v_mul_f32 v138, v138, v68
  v_mul_f32 v139, v139, v68
  v_mul_f32 v140, v140, v68
  v_mul_f32 v141, v141, v68
  v_mul_f32 v142, v142, v68
  v_mul_f32 v143, v143, v68
  v_mul_f32 v144, v144, v68
  v_mul_f32 v145, v145, v68
  v_mul_f32 v146, v146, v68
  v_mul_f32 v147, v147, v68
  v_mul_f32 v148, v148, v68
  v_mul_f32 v149, v149, v68
  v_mul_f32 v150, v150, v68
  v_mul_f32 v151, v151, v68
  v_mul_f32 v152, v152, v68
  v_mul_f32 v153, v153, v68
  v_mul_f32 v154, v154, v68
  v_mul_f32 v155, v155, v68
  v_mul_f32 v156, v156, v68
  v_mul_f32 v157, v157, v68
  v_mul_f32 v158, v158, v68
  v_mul_f32 v159, v159, v68
  v_max3_f32 v73, v36, v37, v38
  v_max3_f32 v73, v73, v39, v52
  v_max3_f32 v73, v73, v53, v54
  v_max3_f32 v73, v73, v55, v65
  v_mov_b32 v77, v73
  s_nop 1
  v_permlane16_swap_b32 v77, v73
  v_max_f32 v73, v73, v77
  v_mov_b32 v77, v73
  s_nop 1
  v_permlane32_swap_b32 v77, v73
  v_max_f32 v73, v73, v77
  v_sub_f32 v77, v65, v73
  v_mul_f32 v77, s20, v77
  v_exp_f32 v69, v77
  v_mov_b32 v65, v73
  v_mul_f32 v21, s43, v73
  v_mul_f32 v81, v81, v69
  v_fma_f32 v36, v36, s20, v21
  v_fma_f32 v37, v37, s20, v21
  v_fma_f32 v38, v38, s20, v21
  v_fma_f32 v39, v39, s20, v21
  v_fma_f32 v52, v52, s20, v21
  v_fma_f32 v53, v53, s20, v21
  v_fma_f32 v54, v54, s20, v21
  v_fma_f32 v55, v55, s20, v21
  v_exp_f32 v36, v36
  v_exp_f32 v37, v37
  v_exp_f32 v38, v38
  v_exp_f32 v39, v39
  v_exp_f32 v52, v52
  v_exp_f32 v53, v53
  v_exp_f32 v54, v54
  v_exp_f32 v55, v55
  v_add_f32 v81, v81, v36
  v_add_f32 v81, v81, v37
  v_add_f32 v81, v81, v38
  v_add_f32 v81, v81, v39
  v_add_f32 v81, v81, v52
  v_add_f32 v81, v81, v53
  v_add_f32 v81, v81, v54
  v_add_f32 v81, v81, v55
  v_cvt_pk_bf16_f32 v100, v36, v37
  v_cvt_pk_bf16_f32 v101, v38, v39
  v_cvt_pk_bf16_f32 v102, v52, v53
  v_cvt_pk_bf16_f32 v103, v54, v55
  v_mul_f32 v160, v160, v69
  v_mul_f32 v161, v161, v69
  v_mul_f32 v162, v162, v69
  v_mul_f32 v163, v163, v69
  v_mul_f32 v164, v164, v69
  v_mul_f32 v165, v165, v69
  v_mul_f32 v166, v166, v69
  v_mul_f32 v167, v167, v69
  v_mul_f32 v168, v168, v69
  v_mul_f32 v169, v169, v69
  v_mul_f32 v170, v170, v69
  v_mul_f32 v171, v171, v69
  v_mul_f32 v172, v172, v69
  v_mul_f32 v173, v173, v69
  v_mul_f32 v174, v174, v69
  v_mul_f32 v175, v175, v69
  v_mul_f32 v176, v176, v69
  v_mul_f32 v177, v177, v69
  v_mul_f32 v178, v178, v69
  v_mul_f32 v179, v179, v69
  v_mul_f32 v180, v180, v69
  v_mul_f32 v181, v181, v69
  v_mul_f32 v182, v182, v69
  v_mul_f32 v183, v183, v69
  v_mul_f32 v184, v184, v69
  v_mul_f32 v185, v185, v69
  v_mul_f32 v186, v186, v69
  v_mul_f32 v187, v187, v69
  v_mul_f32 v188, v188, v69
  v_mul_f32 v189, v189, v69
  v_mul_f32 v190, v190, v69
  v_mul_f32 v191, v191, v69
  v_max3_f32 v74, v40, v41, v42
  v_max3_f32 v74, v74, v43, v56
  v_max3_f32 v74, v74, v57, v58
  v_max3_f32 v74, v74, v59, v66
  v_mov_b32 v78, v74
  s_nop 1
  v_permlane16_swap_b32 v78, v74
  v_max_f32 v74, v74, v78
  v_mov_b32 v78, v74
  s_nop 1
  v_permlane32_swap_b32 v78, v74
  v_max_f32 v74, v74, v78
  v_sub_f32 v78, v66, v74
  v_mul_f32 v78, s20, v78
  v_exp_f32 v70, v78
  v_mov_b32 v66, v74
  v_mul_f32 v22, s43, v74
  v_mul_f32 v82, v82, v70
  v_fma_f32 v40, v40, s20, v22
  v_fma_f32 v41, v41, s20, v22
  v_fma_f32 v42, v42, s20, v22
  v_fma_f32 v43, v43, s20, v22
  v_fma_f32 v56, v56, s20, v22
  v_fma_f32 v57, v57, s20, v22
  v_fma_f32 v58, v58, s20, v22
  v_fma_f32 v59, v59, s20, v22
  v_exp_f32 v40, v40
  v_exp_f32 v41, v41
  v_exp_f32 v42, v42
  v_exp_f32 v43, v43
  v_exp_f32 v56, v56
  v_exp_f32 v57, v57
  v_exp_f32 v58, v58
  v_exp_f32 v59, v59
  v_add_f32 v82, v82, v40
  v_add_f32 v82, v82, v41
  v_add_f32 v82, v82, v42
  v_add_f32 v82, v82, v43
  v_add_f32 v82, v82, v56
  v_add_f32 v82, v82, v57
  v_add_f32 v82, v82, v58
  v_add_f32 v82, v82, v59
  v_cvt_pk_bf16_f32 v104, v40, v41
  v_cvt_pk_bf16_f32 v105, v42, v43
  v_cvt_pk_bf16_f32 v106, v56, v57
  v_cvt_pk_bf16_f32 v107, v58, v59
  v_mul_f32 v192, v192, v70
  v_mul_f32 v193, v193, v70
  v_mul_f32 v194, v194, v70
  v_mul_f32 v195, v195, v70
  v_mul_f32 v196, v196, v70
  v_mul_f32 v197, v197, v70
  v_mul_f32 v198, v198, v70
  v_mul_f32 v199, v199, v70
  v_mul_f32 v200, v200, v70
  v_mul_f32 v201, v201, v70
  v_mul_f32 v202, v202, v70
  v_mul_f32 v203, v203, v70
  v_mul_f32 v204, v204, v70
  v_mul_f32 v205, v205, v70
  v_mul_f32 v206, v206, v70
  v_mul_f32 v207, v207, v70
  v_mul_f32 v208, v208, v70
  v_mul_f32 v209, v209, v70
  v_mul_f32 v210, v210, v70
  v_mul_f32 v211, v211, v70
  v_mul_f32 v212, v212, v70
  v_mul_f32 v213, v213, v70
  v_mul_f32 v214, v214, v70
  v_mul_f32 v215, v215, v70
  v_mul_f32 v216, v216, v70
  v_mul_f32 v217, v217, v70
  v_mul_f32 v218, v218, v70
  v_mul_f32 v219, v219, v70
  v_mul_f32 v220, v220, v70
  v_mul_f32 v221, v221, v70
  v_mul_f32 v222, v222, v70
  v_mul_f32 v223, v223, v70
  v_max3_f32 v75, v44, v45, v46
  v_max3_f32 v75, v75, v47, v60
  v_max3_f32 v75, v75, v61, v62
  v_max3_f32 v75, v75, v63, v67
  v_mov_b32 v79, v75
  s_nop 1
  v_permlane16_swap_b32 v79, v75
  v_max_f32 v75, v75, v79
  v_mov_b32 v79, v75
  s_nop 1
  v_permlane32_swap_b32 v79, v75
  v_max_f32 v75, v75, v79
  v_sub_f32 v79, v67, v75
  v_mul_f32 v79, s20, v79
  v_exp_f32 v71, v79
  v_mov_b32 v67, v75
  v_mul_f32 v23, s43, v75
  v_mul_f32 v83, v83, v71
  v_fma_f32 v44, v44, s20, v23
  v_fma_f32 v45, v45, s20, v23
  v_fma_f32 v46, v46, s20, v23
  v_fma_f32 v47, v47, s20, v23
  v_fma_f32 v60, v60, s20, v23
  v_fma_f32 v61, v61, s20, v23
  v_fma_f32 v62, v62, s20, v23
  v_fma_f32 v63, v63, s20, v23
  v_exp_f32 v44, v44
  v_exp_f32 v45, v45
  v_exp_f32 v46, v46
  v_exp_f32 v47, v47
  v_exp_f32 v60, v60
  v_exp_f32 v61, v61
  v_exp_f32 v62, v62
  v_exp_f32 v63, v63
  v_add_f32 v83, v83, v44
  v_add_f32 v83, v83, v45
  v_add_f32 v83, v83, v46
  v_add_f32 v83, v83, v47
  v_add_f32 v83, v83, v60
  v_add_f32 v83, v83, v61
  v_add_f32 v83, v83, v62
  v_add_f32 v83, v83, v63
  v_cvt_pk_bf16_f32 v108, v44, v45
  v_cvt_pk_bf16_f32 v109, v46, v47
  v_cvt_pk_bf16_f32 v110, v60, v61
  v_cvt_pk_bf16_f32 v111, v62, v63
  v_mul_f32 v224, v224, v71
  v_mul_f32 v225, v225, v71
  v_mul_f32 v226, v226, v71
  v_mul_f32 v227, v227, v71
  v_mul_f32 v228, v228, v71
  v_mul_f32 v229, v229, v71
  v_mul_f32 v230, v230, v71
  v_mul_f32 v231, v231, v71
  v_mul_f32 v232, v232, v71
  v_mul_f32 v233, v233, v71
  v_mul_f32 v234, v234, v71
  v_mul_f32 v235, v235, v71
  v_mul_f32 v236, v236, v71
  v_mul_f32 v237, v237, v71
  v_mul_f32 v238, v238, v71
  v_mul_f32 v239, v239, v71
  v_mul_f32 v240, v240, v71
  v_mul_f32 v241, v241, v71
  v_mul_f32 v242, v242, v71
  v_mul_f32 v243, v243, v71
  v_mul_f32 v244, v244, v71
  v_mul_f32 v245, v245, v71
  v_mul_f32 v246, v246, v71
  v_mul_f32 v247, v247, v71
  v_mul_f32 v248, v248, v71
  v_mul_f32 v249, v249, v71
  v_mul_f32 v250, v250, v71
  v_mul_f32 v251, v251, v71
  v_mul_f32 v252, v252, v71
  v_mul_f32 v253, v253, v71
  v_mul_f32 v254, v254, v71
  v_mul_f32 v255, v255, v71
  v_mfma_f32_16x16x32_bf16 v[128:131], a[160:163], v[96:99], v[128:131]
  v_mfma_f32_16x16x32_bf16 v[160:163], a[160:163], v[100:103], v[160:163]
  v_mfma_f32_16x16x32_bf16 v[132:135], a[164:167], v[96:99], v[132:135]
  v_mfma_f32_16x16x32_bf16 v[164:167], a[164:167], v[100:103], v[164:167]
  v_mfma_f32_16x16x32_bf16 v[136:139], a[168:171], v[96:99], v[136:139]
  v_mfma_f32_16x16x32_bf16 v[168:171], a[168:171], v[100:103], v[168:171]
  v_mfma_f32_16x16x32_bf16 v[140:143], a[172:175], v[96:99], v[140:143]
  v_mfma_f32_16x16x32_bf16 v[172:175], a[172:175], v[100:103], v[172:175]
  v_mfma_f32_16x16x32_bf16 v[144:147], a[176:179], v[96:99], v[144:147]
  v_mfma_f32_16x16x32_bf16 v[176:179], a[176:179], v[100:103], v[176:179]
  v_mfma_f32_16x16x32_bf16 v[148:151], a[180:183], v[96:99], v[148:151]
  v_mfma_f32_16x16x32_bf16 v[180:183], a[180:183], v[100:103], v[180:183]
  v_mfma_f32_16x16x32_bf16 v[152:155], a[184:187], v[96:99], v[152:155]
  v_mfma_f32_16x16x32_bf16 v[184:187], a[184:187], v[100:103], v[184:187]
  v_mfma_f32_16x16x32_bf16 v[156:159], a[188:191], v[96:99], v[156:159]
  v_mfma_f32_16x16x32_bf16 v[188:191], a[188:191], v[100:103], v[188:191]
  v_mfma_f32_16x16x32_bf16 v[192:195], a[160:163], v[104:107], v[192:195]
  v_mfma_f32_16x16x32_bf16 v[224:227], a[160:163], v[108:111], v[224:227]
  v_mfma_f32_16x16x32_bf16 v[196:199], a[164:167], v[104:107], v[196:199]
  v_mfma_f32_16x16x32_bf16 v[228:231], a[164:167], v[108:111], v[228:231]
  v_mfma_f32_16x16x32_bf16 v[200:203], a[168:171], v[104:107], v[200:203]
  v_mfma_f32_16x16x32_bf16 v[232:235], a[168:171], v[108:111], v[232:235]
  v_mfma_f32_16x16x32_bf16 v[204:207], a[172:175], v[104:107], v[204:207]
  v_mfma_f32_16x16x32_bf16 v[236:239], a[172:175], v[108:111], v[236:239]
  v_mfma_f32_16x16x32_bf16 v[208:211], a[176:179], v[104:107], v[208:211]
  v_mfma_f32_16x16x32_bf16 v[240:243], a[176:179], v[108:111], v[240:243]
  v_mfma_f32_16x16x32_bf16 v[212:215], a[180:183], v[104:107], v[212:215]
  v_mfma_f32_16x16x32_bf16 v[244:247], a[180:183], v[108:111], v[244:247]
  v_mfma_f32_16x16x32_bf16 v[216:219], a[184:187], v[104:107], v[216:219]
  v_mfma_f32_16x16x32_bf16 v[248:251], a[184:187], v[108:111], v[248:251]
  v_mfma_f32_16x16x32_bf16 v[220:223], a[188:191], v[104:107], v[220:223]
  v_mfma_f32_16x16x32_bf16 v[252:255], a[188:191], v[108:111], v[252:255]
  s_barrier
  s_add_u32 s16, s16, 0x2000
  s_cmp_lt_u32 s16, 0x20000
  s_cbranch_scc1 L_st
  v_mov_b32 v72, v80
  s_nop 1
  v_permlane16_swap_b32 v72, v80
  v_add_f32 v80, v80, v72
  v_mov_b32 v72, v80
  s_nop 1
  v_permlane32_swap_b32 v72, v80
  v_add_f32 v80, v80, v72
  v_rcp_f32 v24, v80
  v_mov_b32 v73, v81
  s_nop 1
  v_permlane16_swap_b32 v73, v81
  v_add_f32 v81, v81, v73
  v_mov_b32 v73, v81
  s_nop 1
  v_permlane32_swap_b32 v73, v81
  v_add_f32 v81, v81, v73
  v_rcp_f32 v25, v81
  v_mov_b32 v74, v82
  s_nop 1
  v_permlane16_swap_b32 v74, v82
  v_add_f32 v82, v82, v74
  v_mov_b32 v74, v82
  s_nop 1
  v_permlane32_swap_b32 v74, v82
  v_add_f32 v82, v82, v74
  v_rcp_f32 v26, v82
  v_mov_b32 v75, v83
  s_nop 1
  v_permlane16_swap_b32 v75, v83
  v_add_f32 v83, v83, v75
  v_mov_b32 v75, v83
  s_nop 1
  v_permlane32_swap_b32 v75, v83
  v_add_f32 v83, v83, v75
  v_rcp_f32 v27, v83
  v_mul_f32 v128, v128, v24
  v_mul_f32 v129, v129, v24
  v_mul_f32 v130, v130, v24
  v_mul_f32 v131, v131, v24
  v_cvt_pk_bf16_f32 v128, v128, v129
  v_cvt_pk_bf16_f32 v129, v130, v131
  ds_write_b64 v28, v[128:129] offset:0
  v_mul_f32 v160, v160, v25
  v_mul_f32 v161, v161, v25
  v_mul_f32 v162, v162, v25
  v_mul_f32 v163, v163, v25
  v_cvt_pk_bf16_f32 v160, v160, v161
  v_cvt_pk_bf16_f32 v161, v162, v163
  ds_write_b64 v28, v[160:161] offset:4096
  v_xor_b32 v30, 32, v28
  v_mul_f32 v132, v132, v24
  v_mul_f32 v133, v133, v24
  v_mul_f32 v134, v134, v24
  v_mul_f32 v135, v135, v24
  v_cvt_pk_bf16_f32 v132, v132, v133
  v_cvt_pk_bf16_f32 v133, v134, v135
  ds_write_b64 v30, v[132:133] offset:0
  v_mul_f32 v164, v164, v25
  v_mul_f32 v165, v165, v25
  v_mul_f32 v166, v166, v25
  v_mul_f32 v167, v167, v25
  v_cvt_pk_bf16_f32 v164, v164, v165
  v_cvt_pk_bf16_f32 v165, v166, v167
  ds_write_b64 v30, v[164:165] offset:4096
  v_xor_b32 v31, 64, v28
  v_mul_f32 v136, v136, v24
  v_mul_f32 v137, v137, v24
  v_mul_f32 v138, v138, v24
  v_mul_f32 v139, v139, v24
  v_cvt_pk_bf16_f32 v136, v136, v137
  v_cvt_pk_bf16_f32 v137, v138, v139
  ds_write_b64 v31, v[136:137] offset:0
  v_mul_f32 v168, v168, v25
  v_mul_f32 v169, v169, v25
  v_mul_f32 v170, v170, v25
  v_mul_f32 v171, v171, v25
  v_cvt_pk_bf16_f32 v168, v168, v169
  v_cvt_pk_bf16_f32 v169, v170, v171
  ds_write_b64 v31, v[168:169] offset:4096
  v_xor_b32 v30, 96, v28
  v_mul_f32 v140, v140, v24
  v_mul_f32 v141, v141, v24
  v_mul_f32 v142, v142, v24
  v_mul_f32 v143, v143, v24
  v_cvt_pk_bf16_f32 v140, v140, v141
  v_cvt_pk_bf16_f32 v141, v142, v143
  ds_write_b64 v30, v[140:141] offset:0
  v_mul_f32 v172, v172, v25
  v_mul_f32 v173, v173, v25
  v_mul_f32 v174, v174, v25
  v_mul_f32 v175, v175, v25
  v_cvt_pk_bf16_f32 v172, v172, v173
  v_cvt_pk_bf16_f32 v173, v174, v175
  ds_write_b64 v30, v[172:173] offset:4096
  v_xor_b32 v31, 128, v28
  v_mul_f32 v144, v144, v24
  v_mul_f32 v145, v145, v24
  v_mul_f32 v146, v146, v24
  v_mul_f32 v147, v147, v24
  v_cvt_pk_bf16_f32 v144, v144, v145
  v_cvt_pk_bf16_f32 v145, v146, v147
  ds_write_b64 v31, v[144:145] offset:0
  v_mul_f32 v176, v176, v25
  v_mul_f32 v177, v177, v25
  v_mul_f32 v178, v178, v25
  v_mul_f32 v179, v179, v25
  v_cvt_pk_bf16_f32 v176, v176, v177
  v_cvt_pk_bf16_f32 v177, v178, v179
  ds_write_b64 v31, v[176:177] offset:4096
  v_xor_b32 v30, 160, v28
  v_mul_f32 v148, v148, v24
  v_mul_f32 v149, v149, v24
  v_mul_f32 v150, v150, v24
  v_mul_f32 v151, v151, v24
  v_cvt_pk_bf16_f32 v148, v148, v149
  v_cvt_pk_bf16_f32 v149, v150, v151
  ds_write_b64 v30, v[148:149] offset:0
  v_mul_f32 v180, v180, v25
  v_mul_f32 v181, v181, v25
  v_mul_f32 v182, v182, v25
  v_mul_f32 v183, v183, v25
  v_cvt_pk_bf16_f32 v180, v180, v181
  v_cvt_pk_bf16_f32 v181, v182, v183
  ds_write_b64 v30, v[180:181] offset:4096
  v_xor_b32 v31, 192, v28
  v_mul_f32 v152, v152, v24
  v_mul_f32 v153, v153, v24
  v_mul_f32 v154, v154, v24
  v_mul_f32 v155, v155, v24
  v_cvt_pk_bf16_f32 v152, v152, v153
  v_cvt_pk_bf16_f32 v153, v154, v155
  ds_write_b64 v31, v[152:153] offset:0
  v_mul_f32 v184, v184, v25
  v_mul_f32 v185, v185, v25
  v_mul_f32 v186, v186, v25
  v_mul_f32 v187, v187, v25
  v_cvt_pk_bf16_f32 v184, v184, v185
  v_cvt_pk_bf16_f32 v185, v186, v187
  ds_write_b64 v31, v[184:185] offset:4096
  v_xor_b32 v30, 224, v28
  v_mul_f32 v156, v156, v24
  v_mul_f32 v157, v157, v24
  v_mul_f32 v158, v158, v24
  v_mul_f32 v159, v159, v24
  v_cvt_pk_bf16_f32 v156, v156, v157
  v_cvt_pk_bf16_f32 v157, v158, v159
  ds_write_b64 v30, v[156:157] offset:0
  v_mul_f32 v188, v188, v25
  v_mul_f32 v189, v189, v25
  v_mul_f32 v190, v190, v25
  v_mul_f32 v191, v191, v25
  v_cvt_pk_bf16_f32 v188, v188, v189
  v_cvt_pk_bf16_f32 v189, v190, v191
  ds_write_b64 v30, v[188:189] offset:4096
  v_mul_f32 v192, v192, v26
  v_mul_f32 v193, v193, v26
  v_mul_f32 v194, v194, v26
  v_mul_f32 v195, v195, v26
  v_cvt_pk_bf16_f32 v192, v192, v193
  v_cvt_pk_bf16_f32 v193, v194, v195
  ds_write_b64 v28, v[192:193] offset:8192
  v_mul_f32 v224, v224, v27
  v_mul_f32 v225, v225, v27
  v_mul_f32 v226, v226, v27
  v_mul_f32 v227, v227, v27
  v_cvt_pk_bf16_f32 v224, v224, v225
  v_cvt_pk_bf16_f32 v225, v226, v227
  ds_write_b64 v28, v[224:225] offset:12288
  v_xor_b32 v31, 32, v28
  v_mul_f32 v196, v196, v26
  v_mul_f32 v197, v197, v26
  v_mul_f32 v198, v198, v26
  v_mul_f32 v199, v199, v26
  v_cvt_pk_bf16_f32 v196, v196, v197
  v_cvt_pk_bf16_f32 v197, v198, v199
  ds_write_b64 v31, v[196:197] offset:8192
  v_mul_f32 v228, v228, v27
  v_mul_f32 v229, v229, v27
  v_mul_f32 v230, v230, v27
  v_mul_f32 v231, v231, v27
  v_cvt_pk_bf16_f32 v228, v228, v229
  v_cvt_pk_bf16_f32 v229, v230, v231
  ds_write_b64 v31, v[228:229] offset:12288
  v_xor_b32 v30, 64, v28
  v_mul_f32 v200, v200, v26
  v_mul_f32 v201, v201, v26
  v_mul_f32 v202, v202, v26
  v_mul_f32 v203, v203, v26
  v_cvt_pk_bf16_f32 v200, v200, v201
  v_cvt_pk_bf16_f32 v201, v202, v203
  ds_write_b64 v30, v[200:201] offset:8192
  v_mul_f32 v232, v232, v27
  v_mul_f32 v233, v233, v27
  v_mul_f32 v234, v234, v27
  v_mul_f32 v235, v235, v27
  v_cvt_pk_bf16_f32 v232, v232, v233
  v_cvt_pk_bf16_f32 v233, v234, v235
  ds_write_b64 v30, v[232:233] offset:12288
  v_xor_b32 v31, 96, v28
  v_mul_f32 v204, v204, v26
  v_mul_f32 v205, v205, v26
  v_mul_f32 v206, v206, v26
  v_mul_f32 v207, v207, v26
  v_cvt_pk_bf16_f32 v204, v204, v205
  v_cvt_pk_bf16_f32 v205, v206, v207
  ds_write_b64 v31, v[204:205] offset:8192
  v_mul_f32 v236, v236, v27
  v_mul_f32 v237, v237, v27
  v_mul_f32 v238, v238, v27
  v_mul_f32 v239, v239, v27
  v_cvt_pk_bf16_f32 v236, v236, v237
  v_cvt_pk_bf16_f32 v237, v238, v239
  ds_write_b64 v31, v[236:237] offset:12288
  v_xor_b32 v30, 128, v28
  v_mul_f32 v208, v208, v26
  v_mul_f32 v209, v209, v26
  v_mul_f32 v210, v210, v26
  v_mul_f32 v211, v211, v26
  v_cvt_pk_bf16_f32 v208, v208, v209
  v_cvt_pk_bf16_f32 v209, v210, v211
  ds_write_b64 v30, v[208:209] offset:8192
  v_mul_f32 v240, v240, v27
  v_mul_f32 v241, v241, v27
  v_mul_f32 v242, v242, v27
  v_mul_f32 v243, v243, v27
  v_cvt_pk_bf16_f32 v240, v240, v241
  v_cvt_pk_bf16_f32 v241, v242, v243
  ds_write_b64 v30, v[240:241] offset:12288
  v_xor_b32 v31, 160, v28
  v_mul_f32 v212, v212, v26
  v_mul_f32 v213, v213, v26
  v_mul_f32 v214, v214, v26
  v_mul_f32 v215, v215, v26
  v_cvt_pk_bf16_f32 v212, v212, v213
  v_cvt_pk_bf16_f32 v213, v214, v215
  ds_write_b64 v31, v[212:213] offset:8192
  v_mul_f32 v244, v244, v27
  v_mul_f32 v245, v245, v27
  v_mul_f32 v246, v246, v27
  v_mul_f32 v247, v247, v27
  v_cvt_pk_bf16_f32 v244, v244, v245
  v_cvt_pk_bf16_f32 v245, v246, v247
  ds_write_b64 v31, v[244:245] offset:12288
  v_xor_b32 v30, 192, v28
  v_mul_f32 v216, v216, v26
  v_mul_f32 v217, v217, v26
  v_mul_f32 v218, v218, v26
  v_mul_f32 v219, v219, v26
  v_cvt_pk_bf16_f32 v216, v216, v217
  v_cvt_pk_bf16_f32 v217, v218, v219
  ds_write_b64 v30, v[216:217] offset:8192
  v_mul_f32 v248, v248, v27
  v_mul_f32 v249, v249, v27
  v_mul_f32 v250, v250, v27
  v_mul_f32 v251, v251, v27
  v_cvt_pk_bf16_f32 v248, v248, v249
  v_cvt_pk_bf16_f32 v249, v250, v251
  ds_write_b64 v30, v[248:249] offset:12288
  v_xor_b32 v31, 224, v28
  v_mul_f32 v220, v220, v26
  v_mul_f32 v221, v221, v26
  v_mul_f32 v222, v222, v26
  v_mul_f32 v223, v223, v26
  v_cvt_pk_bf16_f32 v220, v220, v221
  v_cvt_pk_bf16_f32 v221, v222, v223
  ds_write_b64 v31, v[220:221] offset:8192
  v_mul_f32 v252, v252, v27
  v_mul_f32 v253, v253, v27
  v_mul_f32 v254, v254, v27
  v_mul_f32 v255, v255, v27
  v_cvt_pk_bf16_f32 v252, v252, v253
  v_cvt_pk_bf16_f32 v253, v254, v255
  ds_write_b64 v31, v[252:253] offset:12288
  ds_read_b128 a[192:195], v29 offset:0
  ds_read_b128 a[196:199], v29 offset:1024
  ds_read_b128 a[200:203], v29 offset:2048
  ds_read_b128 a[204:207], v29 offset:3072
  ds_read_b128 a[208:211], v29 offset:4096
  ds_read_b128 a[212:215], v29 offset:5120
  ds_read_b128 a[216:219], v29 offset:6144
  ds_read_b128 a[220:223], v29 offset:7168
  ds_read_b128 a[224:227], v29 offset:8192
  ds_read_b128 a[228:231], v29 offset:9216
  ds_read_b128 a[232:235], v29 offset:10240
  ds_read_b128 a[236:239], v29 offset:11264
  ds_read_b128 a[240:243], v29 offset:12288
  ds_read_b128 a[244:247], v29 offset:13312
  ds_read_b128 a[248:251], v29 offset:14336
  ds_read_b128 a[252:255], v29 offset:15360
  s_waitcnt lgkmcnt(0)
  buffer_store_dwordx4 a[192:195], v16, s[12:15], 0 offen offset:0 nt
  buffer_store_dwordx4 a[196:199], v17, s[12:15], 0 offen offset:1024 nt
  buffer_store_dwordx4 a[200:203], v18, s[12:15], 0 offen offset:2048 nt
  buffer_store_dwordx4 a[204:207], v19, s[12:15], 0 offen offset:3072 nt
  buffer_store_dwordx4 a[208:211], v16, s[12:15], s87 offen offset:0 nt
  buffer_store_dwordx4 a[212:215], v17, s[12:15], s87 offen offset:1024 nt
  buffer_store_dwordx4 a[216:219], v18, s[12:15], s87 offen offset:2048 nt
  buffer_store_dwordx4 a[220:223], v19, s[12:15], s87 offen offset:3072 nt
  buffer_store_dwordx4 a[224:227], v16, s[12:15], s88 offen offset:0 nt
  buffer_store_dwordx4 a[228:231], v17, s[12:15], s88 offen offset:1024 nt
  buffer_store_dwordx4 a[232:235], v18, s[12:15], s88 offen offset:2048 nt
  buffer_store_dwordx4 a[236:239], v19, s[12:15], s88 offen offset:3072 nt
  buffer_store_dwordx4 a[240:243], v16, s[12:15], s89 offen offset:0 nt
  buffer_store_dwordx4 a[244:247], v17, s[12:15], s89 offen offset:1024 nt
  buffer_store_dwordx4 a[248:251], v18, s[12:15], s89 offen offset:2048 nt
  buffer_store_dwordx4 a[252:255], v19, s[12:15], s89 offen offset:3072 nt
L_sb_next:
  s_add_u32 s21, s21, 1
  s_cmp_lt_u32 s21, 4
  s_cbranch_scc1 L_sb
L_fin:
L_end:
L_codeend:
  s_endpgm
.section .rodata,"a"
.p2align 6
.amdhsa_kernel standalone__mha_softmax__near_ridge_kernel
  .amdhsa_next_free_vgpr 512
  .amdhsa_next_free_sgpr 96
  .amdhsa_accum_offset 256
  .amdhsa_group_segment_fixed_size 0
  .amdhsa_kernarg_size 48
  .amdhsa_user_sgpr_count 2
  .amdhsa_user_sgpr_kernarg_segment_ptr 1
  .amdhsa_system_sgpr_workgroup_id_x 1
  .amdhsa_float_denorm_mode_32 3
.end_amdhsa_kernel
```
